```python
import torch

def _softmax(x, axis=-1):
    return torch.softmax(x, dim=axis)
def _gelu(x):
    return torch.nn.functional.gelu(x, approximate="tanh")
def _silu(x):
    return torch.nn.functional.silu(x)
def _sigmoid(x):
    return torch.sigmoid(x)
def _layernorm(x, axis=-1, eps=1e-5):
    m = x.mean(dim=axis, keepdim=True)
    v = x.var(dim=axis, keepdim=True, unbiased=False)
    return (x - m) / torch.sqrt(v + eps)
def _scatter_add(tgt, idx, src, axis=0):
    return tgt.clone().index_add_(axis, idx, src)
def _segment_sum(src, seg, n):
    out = torch.zeros((n,) + src.shape[1:], dtype=src.dtype)
    return out.index_add_(0, seg, src)
def _pad(x, pw):
    flat = tuple(v for pair in reversed(pw) for v in pair)
    return torch.nn.functional.pad(x, flat)

kernel_name = 'gated_mix__ssm_conv_h3__dense_activation_gelu__prompt'

def setup_inputs():

    _w = (lambda a: (lambda t: t.to(torch.bfloat16) if t.is_floating_point() else t)(torch.as_tensor(a)))
    def _A_setup():
        B, S, D = 1, 2048, 640
        ks = 4
        return {
            "q": _w((lambda *s: torch.randn(*s, dtype=torch.bfloat16) * 0.05)(B, S, D)),
            "k": _w((lambda *s: torch.randn(*s, dtype=torch.bfloat16) * 0.2)(B, S, D)),
            "v": _w((lambda *s: torch.randn(*s, dtype=torch.bfloat16) * 0.2)(B, S, D)),
            "shift_k": _w((lambda *s: torch.randn(*s, dtype=torch.bfloat16) * 0.2)(D, ks) * 0.5),
            "ssm_k": _w((lambda *s: torch.randn(*s, dtype=torch.bfloat16) * 0.8)(D, S) * (1.0 / S ** 0.5)),
            "ssm_D": _w((lambda *s: torch.randn(*s, dtype=torch.bfloat16) * 0.2)(D)),
        }
    _A_in = _A_setup()

    def _B_setup():
        B, S, D, F = 1, 2048, 640, 1536
        return {
            "x": _w((lambda *s: torch.randn(*s, dtype=torch.bfloat16) * 0.05)(B, S, D)),
            "w1": _w((lambda *s: torch.randn(*s, dtype=torch.bfloat16) * 3.2)(D, F) * (D ** -0.5)),
            "b1": _w((lambda *s: torch.randn(*s, dtype=torch.bfloat16) * 3.2)(F) * 0.01),
            "w2": _w((lambda *s: torch.randn(*s, dtype=torch.bfloat16) * 0.05)(F, D) * (F ** -0.5)),
            "b2": _w((lambda *s: torch.randn(*s, dtype=torch.bfloat16) * 0.1)(D) * 0.01),
        }
    _B_in = _B_setup()

    return {
        "A_q": _A_in["q"],
        "A_k": _A_in["k"],
        "A_v": _A_in["v"],
        "A_shift_k": _A_in["shift_k"],
        "A_ssm_k": _A_in["ssm_k"],
        "A_ssm_D": _A_in["ssm_D"],
        "B_x": _B_in["x"],
        "B_w1": _B_in["w1"],
        "B_b1": _B_in["b1"],
        "B_w2": _B_in["w2"],
        "B_b2": _B_in["b2"],
        "gate_w": _w((lambda *s: torch.randn(*s, dtype=torch.bfloat16) * 0.05)(640) * 16.0),
    }

def reference(A_q, A_k, A_v, A_shift_k, A_ssm_k, A_ssm_D, B_x, B_w1, B_b1, B_w2, B_b2, gate_w):
    def _A_ref(q, k, v, shift_k, ssm_k, ssm_D):
        B, S, D = q.shape
        ks = shift_k.shape[-1]
        k_pad = _pad(k, ((0, 0), (ks - 1, 0), (0, 0)))
        k_shift = torch.zeros_like(k)
        for t in range(ks):
            k_shift = k_shift + k_pad[:, t:t + S, :] * shift_k[:, ks - 1 - t][None, None, :]
        kv = k_shift * v
        L = 2 * S
        kv_pad = _pad(kv, ((0, 0), (0, S), (0, 0)))
        kf_pad = _pad(ssm_k, ((0, 0), (0, S)))
        kv_f = (lambda x, axes=(-2,-1): torch.fft.rfft2(x.float(), dim=axes))(kv_pad[:, None, :, :], axes=(1, 2))
        kf_f = (lambda x, axes=(-2,-1): torch.fft.rfft2(x.float(), dim=axes))(kf_pad[:, None, :], axes=(1, 2))
        kf_f = (lambda x, *d: x.permute(*d))(kf_f, 1, 2, 0)
        y_f = kv_f * kf_f[None, :, :, :]
        y = (lambda x, s, axes=(-2,-1): torch.fft.irfft2(x, s=s, dim=axes).to(torch.bfloat16))(y_f, (1, L), axes=(1, 2))[:, 0, :S, :]
        y = y + kv * ssm_D[None, None, :]
        return q * y

    def _B_ref(x, w1, b1, w2, b2):
        h = torch.einsum("bsd,df->bsf", x, w1) + b1
        h = _gelu(h)
        return torch.einsum("bsf,fd->bsd", h, w2) + b2

    x = A_q
    g = _sigmoid((x * gate_w).sum(-1, keepdims=True))
    a = _A_ref(x, A_k, A_v, A_shift_k, A_ssm_k, A_ssm_D)
    b = _B_ref(x, B_w1, B_b1, B_w2, B_b2)
    return g * a + (1 - g) * b
```

```asm
; @launch grid=(256,1,1) block=(512,1,1) lds=163840
.amdgcn_target "amdgcn-amd-amdhsa--gfx950"
.text
.globl gated_mix__ssm_conv_h3__dense_activation_gelu__prompt_kernel
.p2align 8
.type gated_mix__ssm_conv_h3__dense_activation_gelu__prompt_kernel,@function
gated_mix__ssm_conv_h3__dense_activation_gelu__prompt_kernel:
  s_cmp_ge_u32 s2, 256
  s_cbranch_scc1 L_end
  s_load_dwordx16 s[16:31], s[0:1], 0
  s_load_dwordx8 s[32:39], s[0:1], 64
  s_load_dwordx4 s[40:43], s[0:1], 96
  s_load_dwordx2 s[44:45], s[0:1], 112
  s_getpc_b64 s[94:95]
  v_and_b32 v1, 63, v0
  v_lshrrev_b32 v2, 6, v0
  s_nop 0
  v_readfirstlane_b32 s3, v2
  s_and_b32 s4, s2, 7
  s_lshr_b32 s5, s2, 3
  s_lshr_b32 s10, s4, 1
  s_and_b32 s11, s4, 1
  s_lshl_b32 s8, s10, 3
  s_lshr_b32 s12, s5, 2
  s_add_u32 s8, s8, s12
  s_lshl_b32 s9, s11, 2
  s_and_b32 s12, s5, 3
  s_add_u32 s9, s9, s12
  s_mul_i32 s12, s5, 43
  s_lshr_b32 s12, s12, 8
  s_mul_i32 s13, s12, 6
  s_sub_u32 s13, s5, s13
  s_lshl_b32 s6, s10, 2
  s_add_u32 s6, s6, s12
  s_mul_i32 s7, s11, 6
  s_add_u32 s7, s7, s13
  s_and_b32 s77, s3, 3
  v_and_b32 v2, 15, v1
  v_lshrrev_b32 v3, 4, v1
  v_lshlrev_b32 v4, 4, v1
  s_cmp_ge_u32 s5, 24
  s_cbranch_scc1 L_H
  s_cmp_lt_u32 s3, 4
  s_cbranch_scc1 L_G
  s_mul_i32 s90, s13, 427
  s_lshr_b32 s90, s90, 8
  s_mul_i32 s12, s12, 5
  s_lshr_b32 s12, s12, 1
  s_add_u32 s90, s90, s12
  s_sub_u32 s10, s90, 10
  s_cmp_ge_u32 s90, 10
  s_cselect_b32 s90, s10, s90
  s_sub_u32 s10, s90, 10
  s_cmp_ge_u32 s90, 10
  s_cselect_b32 s90, s10, s90
  v_lshrrev_b32 v6, 3, v1
  v_and_b32 v7, 7, v1
  s_lshl_b32 s10, s6, 7
  s_lshl_b32 s11, s77, 5
  s_add_u32 s10, s10, s11
  v_add_u32 v16, 0, v6
  v_bfe_u32 v17, v16, 1, 3
  v_xor_b32 v17, v17, v7
  v_add_u32 v16, s10, v16
  v_mul_u32_u24 v16, 1280, v16
  v_lshl_add_u32 v16, v17, 4, v16
  v_subrev_u32 v8, 0, v16
  v_add_u32 v16, 8, v6
  v_bfe_u32 v17, v16, 1, 3
  v_xor_b32 v17, v17, v7
  v_add_u32 v16, s10, v16
  v_mul_u32_u24 v16, 1280, v16
  v_lshl_add_u32 v16, v17, 4, v16
  v_subrev_u32 v9, 1024, v16
  v_add_u32 v16, 16, v6
  v_bfe_u32 v17, v16, 1, 3
  v_xor_b32 v17, v17, v7
  v_add_u32 v16, s10, v16
  v_mul_u32_u24 v16, 1280, v16
  v_lshl_add_u32 v16, v17, 4, v16
  v_subrev_u32 v10, 2048, v16
  v_add_u32 v16, 24, v6
  v_bfe_u32 v17, v16, 1, 3
  v_xor_b32 v17, v17, v7
  v_add_u32 v16, s10, v16
  v_mul_u32_u24 v16, 1280, v16
  v_lshl_add_u32 v16, v17, 4, v16
  v_subrev_u32 v11, 3072, v16
  v_bfe_u32 v16, v1, 3, 2
  v_mul_u32_u24 v16, 3072, v16
  v_lshrrev_b32 v17, 5, v1
  v_lshl_add_u32 v16, v17, 7, v16
  v_bfe_u32 v17, v1, 4, 1
  v_lshlrev_b32 v17, 2, v17
  v_xor_b32 v17, v17, v7
  v_lshl_add_u32 v12, v17, 4, v16
  s_lshl_b32 s76, s7, 8
  s_mul_i32 s10, s77, 49152
  s_add_u32 s76, s76, s10
  s_mov_b32 s96, 0
  s_mov_b32 s80, 0
  s_lshl_b32 s82, s77, 12
  s_mul_i32 s83, s77, 4160
  s_add_u32 s83, s83, 16384
  s_waitcnt lgkmcnt(0)
  s_mov_b32 s48, s16
  s_mov_b32 s49, s17
  s_mov_b32 s50, 0x280000
  s_mov_b32 s51, 0x20000
  s_mov_b32 s52, s30
  s_mov_b32 s53, s31
  s_mov_b32 s54, 0x1e0000
  s_mov_b32 s55, 0x20000
  s_lshl_b32 s78, s90, 7
  s_mul_i32 s79, s90, 196608
  s_add_u32 s79, s79, s76
  s_add_u32 m0, s80, s82
  s_add_u32 s13, s80, s83
  buffer_load_dwordx4 v8, s[48:51], s78 offen offset:0 lds
  buffer_load_dwordx4 v9, s[48:51], s78 offen offset:1024 lds
  buffer_load_dwordx4 v10, s[48:51], s78 offen offset:2048 lds
  buffer_load_dwordx4 v11, s[48:51], s78 offen offset:3072 lds
  s_add_u32 m0, s13, 0
  s_nop 0
  buffer_load_dwordx4 v12, s[52:55], s79 offen lds
  s_add_u32 s79, s79, 12288
  s_add_u32 m0, s13, 1024
  s_nop 0
  buffer_load_dwordx4 v12, s[52:55], s79 offen lds
  s_add_u32 s79, s79, 12288
  s_add_u32 m0, s13, 2080
  s_nop 0
  buffer_load_dwordx4 v12, s[52:55], s79 offen lds
  s_add_u32 s79, s79, 12288
  s_add_u32 m0, s13, 3104
  s_nop 0
  buffer_load_dwordx4 v12, s[52:55], s79 offen lds
  s_add_u32 s90, s90, 1
  s_cmp_eq_u32 s90, 10
  s_cselect_b32 s90, 0, s90
  s_add_u32 s80, s80, 33024
  s_cmp_eq_u32 s80, 132096
  s_cselect_b32 s80, 0, s80
  s_add_u32 s96, s96, 1
  s_mul_i32 s10, s4, 24
  s_add_u32 s10, s10, s5
  s_lshl_b32 s10, s10, 1
  s_lshr_b32 s99, s77, 1
  s_add_u32 s84, s10, s99
  s_add_u32 s84, s84, 256
  s_mul_i32 s85, s99, 21248
  s_add_u32 s85, s85, 114688
  s_lshl_b32 s78, s90, 7
  s_mul_i32 s79, s90, 196608
  s_add_u32 s79, s79, s76
  s_add_u32 m0, s80, s82
  s_add_u32 s13, s80, s83
  buffer_load_dwordx4 v8, s[48:51], s78 offen offset:0 lds
  buffer_load_dwordx4 v9, s[48:51], s78 offen offset:1024 lds
  buffer_load_dwordx4 v10, s[48:51], s78 offen offset:2048 lds
  buffer_load_dwordx4 v11, s[48:51], s78 offen offset:3072 lds
  s_add_u32 m0, s13, 0
  s_nop 0
  buffer_load_dwordx4 v12, s[52:55], s79 offen lds
  s_add_u32 s79, s79, 12288
  s_add_u32 m0, s13, 1024
  s_nop 0
  buffer_load_dwordx4 v12, s[52:55], s79 offen lds
  s_add_u32 s79, s79, 12288
  s_add_u32 m0, s13, 2080
  s_nop 0
  buffer_load_dwordx4 v12, s[52:55], s79 offen lds
  s_add_u32 s79, s79, 12288
  s_add_u32 m0, s13, 3104
  s_nop 0
  buffer_load_dwordx4 v12, s[52:55], s79 offen lds
  s_add_u32 s90, s90, 1
  s_cmp_eq_u32 s90, 10
  s_cselect_b32 s90, 0, s90
  s_add_u32 s80, s80, 33024
  s_cmp_eq_u32 s80, 132096
  s_cselect_b32 s80, 0, s80
  s_add_u32 s96, s96, 1
  s_mov_b32 s56, s44
  s_mov_b32 s57, s45
  s_mov_b32 s58, 0x1000000
  s_mov_b32 s59, 0x20000
  s_waitcnt vmcnt(8)
  s_barrier
  s_lshl_b32 s78, s90, 7
  s_mul_i32 s79, s90, 196608
  s_add_u32 s79, s79, s76
  s_add_u32 m0, s80, s82
  s_add_u32 s13, s80, s83
  buffer_load_dwordx4 v8, s[48:51], s78 offen offset:0 lds
  buffer_load_dwordx4 v9, s[48:51], s78 offen offset:1024 lds
  buffer_load_dwordx4 v10, s[48:51], s78 offen offset:2048 lds
  buffer_load_dwordx4 v11, s[48:51], s78 offen offset:3072 lds
  s_add_u32 m0, s13, 0
  s_nop 0
  buffer_load_dwordx4 v12, s[52:55], s79 offen lds
  s_add_u32 s79, s79, 12288
  s_add_u32 m0, s13, 1024
  s_nop 0
  buffer_load_dwordx4 v12, s[52:55], s79 offen lds
  s_add_u32 s79, s79, 12288
  s_add_u32 m0, s13, 2080
  s_nop 0
  buffer_load_dwordx4 v12, s[52:55], s79 offen lds
  s_add_u32 s79, s79, 12288
  s_add_u32 m0, s13, 3104
  s_nop 0
  buffer_load_dwordx4 v12, s[52:55], s79 offen lds
  s_add_u32 s90, s90, 1
  s_cmp_eq_u32 s90, 10
  s_cselect_b32 s90, 0, s90
  s_add_u32 s80, s80, 33024
  s_cmp_eq_u32 s80, 132096
  s_cselect_b32 s80, 0, s80
  s_add_u32 s96, s96, 1
  s_lshl_b32 s78, s90, 7
  s_mul_i32 s79, s90, 196608
  s_add_u32 s79, s79, s76
  s_add_u32 m0, s80, s82
  s_add_u32 s13, s80, s83
  buffer_load_dwordx4 v8, s[48:51], s78 offen offset:0 lds
  buffer_load_dwordx4 v9, s[48:51], s78 offen offset:1024 lds
  buffer_load_dwordx4 v10, s[48:51], s78 offen offset:2048 lds
  buffer_load_dwordx4 v11, s[48:51], s78 offen offset:3072 lds
  s_add_u32 m0, s13, 0
  s_nop 0
  buffer_load_dwordx4 v12, s[52:55], s79 offen lds
  s_add_u32 s79, s79, 12288
  s_add_u32 m0, s13, 1024
  s_nop 0
  buffer_load_dwordx4 v12, s[52:55], s79 offen lds
  s_add_u32 s79, s79, 12288
  s_add_u32 m0, s13, 2080
  s_nop 0
  buffer_load_dwordx4 v12, s[52:55], s79 offen lds
  s_add_u32 s79, s79, 12288
  s_add_u32 m0, s13, 3104
  s_nop 0
  buffer_load_dwordx4 v12, s[52:55], s79 offen lds
  s_add_u32 s90, s90, 1
  s_cmp_eq_u32 s90, 10
  s_cselect_b32 s90, 0, s90
  s_add_u32 s80, s80, 33024
  s_cmp_eq_u32 s80, 132096
  s_cselect_b32 s80, 0, s80
  s_add_u32 s96, s96, 1
L_ld_loop:
  s_waitcnt vmcnt(16)
  s_barrier
  s_lshl_b32 s78, s90, 7
  s_mul_i32 s79, s90, 196608
  s_add_u32 s79, s79, s76
  s_add_u32 m0, s80, s82
  s_add_u32 s13, s80, s83
  buffer_load_dwordx4 v8, s[48:51], s78 offen offset:0 lds
  buffer_load_dwordx4 v9, s[48:51], s78 offen offset:1024 lds
  buffer_load_dwordx4 v10, s[48:51], s78 offen offset:2048 lds
  buffer_load_dwordx4 v11, s[48:51], s78 offen offset:3072 lds
  s_add_u32 m0, s13, 0
  s_nop 0
  buffer_load_dwordx4 v12, s[52:55], s79 offen lds
  s_add_u32 s79, s79, 12288
  s_add_u32 m0, s13, 1024
  s_nop 0
  buffer_load_dwordx4 v12, s[52:55], s79 offen lds
  s_add_u32 s79, s79, 12288
  s_add_u32 m0, s13, 2080
  s_nop 0
  buffer_load_dwordx4 v12, s[52:55], s79 offen lds
  s_add_u32 s79, s79, 12288
  s_add_u32 m0, s13, 3104
  s_nop 0
  buffer_load_dwordx4 v12, s[52:55], s79 offen lds
  s_add_u32 s90, s90, 1
  s_cmp_eq_u32 s90, 10
  s_cselect_b32 s90, 0, s90
  s_add_u32 s80, s80, 33024
  s_cmp_eq_u32 s80, 132096
  s_cselect_b32 s80, 0, s80
  s_add_u32 s96, s96, 1
  s_cmp_lt_u32 s96, 10
  s_cbranch_scc1 L_ld_loop
  v_mov_b32 v6, 0
  global_load_dword v5, v6, s[42:43] sc1
  s_waitcnt vmcnt(17)
  s_barrier
  s_min_u32 s11, s7, 7
  s_lshl_b32 s11, s11, 4
  s_lshl_b32 s10, s6, 7
  s_add_u32 s10, s10, s11
  s_lshl_b32 s11, s77, 2
  s_add_u32 s10, s10, s11
  v_add_u32 v20, s10, v3
  v_lshrrev_b32 v34, 2, v20
  v_lshlrev_b32 v34, 7, v34
  v_lshl_add_u32 v34, v3, 3, v34
  v_lshlrev_b32 v21, 4, v2
  v_mul_u32_u24 v22, 1280, v20
  v_add_u32 v22, v22, v21
  global_load_dwordx4 v[200:203], v22, s[16:17] offset:0
  global_load_dwordx4 v[220:223], v21, s[38:39] offset:0
  global_load_dwordx4 v[204:207], v22, s[16:17] offset:256
  global_load_dwordx4 v[224:227], v21, s[38:39] offset:256
  global_load_dwordx4 v[208:211], v22, s[16:17] offset:512
  global_load_dwordx4 v[228:231], v21, s[38:39] offset:512
  global_load_dwordx4 v[212:215], v22, s[16:17] offset:768
  global_load_dwordx4 v[232:235], v21, s[38:39] offset:768
  global_load_dwordx4 v[216:219], v22, s[16:17] offset:1024
  global_load_dwordx4 v[236:239], v21, s[38:39] offset:1024
  s_waitcnt vmcnt(19)
  s_barrier
  s_and_b32 s13, s3, 1
  s_lshl_b32 s13, s13, 1
  s_mov_b32 s68, s24
  s_mov_b32 s69, s25
  s_mov_b32 s70, 0x280000
  s_mov_b32 s71, 0x20000
  s_lshl_b32 s10, s84, 12
  s_add_u32 s12, s13, 0
  s_lshl_b32 s11, s12, 1
  s_add_u32 s11, s11, s10
  s_mul_i32 s12, s12, 4160
  s_add_u32 s12, s12, s85
  s_add_u32 m0, s12, 32
  s_nop 0
  buffer_load_dwordx4 v4, s[68:71], s11 offen offset:0 lds
  buffer_load_dwordx4 v4, s[68:71], s11 offen offset:1024 lds
  buffer_load_dwordx4 v4, s[68:71], s11 offen offset:2048 lds
  buffer_load_dwordx4 v4, s[68:71], s11 offen offset:3072 lds
  s_add_u32 s12, s13, 1
  s_lshl_b32 s11, s12, 1
  s_add_u32 s11, s11, s10
  s_mul_i32 s12, s12, 4160
  s_add_u32 s12, s12, s85
  s_add_u32 m0, s12, 32
  s_nop 0
  buffer_load_dwordx4 v4, s[68:71], s11 offen offset:0 lds
  buffer_load_dwordx4 v4, s[68:71], s11 offen offset:1024 lds
  buffer_load_dwordx4 v4, s[68:71], s11 offen offset:2048 lds
  buffer_load_dwordx4 v4, s[68:71], s11 offen offset:3072 lds
  s_lshl_b32 s10, s84, 12
  v_mov_b32 v6, s10
  global_load_dwordx2 v[128:129], v6, s[24:25]
  s_lshl_b32 s10, s84, 1
  v_mov_b32 v6, s10
  global_load_ushort v15, v6, s[26:27]
  s_waitcnt vmcnt(20)
  v_cmp_eq_u32 vcc, 0, v5
  s_nop 0
  s_cbranch_vccz L_ld_tag
  s_mov_b32 s92, 0x40000
  v_mov_b32 v6, 0
L_nct_1:
  global_load_dword v5, v6, s[42:43] sc1
  s_waitcnt vmcnt(0)
  v_cmp_eq_u32 vcc, 0, v5
  s_nop 0
  s_cbranch_vccz L_ncd_2
  s_sleep 2
  s_sub_u32 s92, s92, 1
  s_cmp_lg_u32 s92, 0
  s_cbranch_scc1 L_nct_1
L_ncd_2:
L_ld_tag:
  v_mov_b32 v7, 157184
  ds_write_b32 v7, v5
  s_waitcnt lgkmcnt(0)
  s_barrier
  s_setprio 1
  s_and_b32 s10, s3, 1
  s_cmp_eq_u32 s10, 0
  s_cbranch_scc1 L_nocp
  s_waitcnt vmcnt(0)
  v_add_u32 v10, s85, v4
  v_alignbit_b32 v144, v129, v128, 16
  v_mov_b32 v20, 0
  v_mov_b32 v21, 0
  v_mov_b32 v22, 0
  v_mov_b32 v23, 0
  s_mov_b64 exec, 0x3fffffff
  ds_write_b128 v10, v[20:23] offset:20736
  s_mov_b64 exec, 3
  ds_write_b128 v10, v[20:23] offset:0
  ds_write_b128 v10, v[20:23] offset:4160
  ds_write_b128 v10, v[20:23] offset:8320
  ds_write_b128 v10, v[20:23] offset:12480
  s_mov_b64 exec, 1
  v_lshlrev_b32 v24, 16, v128
  ds_write_b32 v10, v24 offset:4188
  ds_write_b32 v10, v128 offset:8348
  ds_write_b32 v10, v24 offset:12504
  ds_write_b32 v10, v144 offset:12508
  s_mov_b64 exec, -1
L_nocp:
  s_lshl_b32 s10, s77, 2
  s_add_u32 s10, s10, 157248
  v_mov_b32 v6, s10
  s_lshl_b32 s10, s77, 13
  s_add_u32 s10, s10, 66048
  v_add_u32 v8, s10, v4
  s_mov_b32 s92, 0x100000
L_lw_3:
  ds_read_b32 v9, v6 offset:0
  s_waitcnt lgkmcnt(0)
  v_cmp_eq_u32 vcc, 0, v9
  s_nop 0
  s_cbranch_vccz L_lwd_4
  s_sub_u32 s92, s92, 1
  s_cmp_lg_u32 s92, 0
  s_cbranch_scc1 L_lw_3
L_lwd_4:
  ds_read_b128 v[64:67], v8 offset:0
  ds_read_b128 v[68:71], v8 offset:1024
  ds_read_b128 v[72:75], v8 offset:2048
  ds_read_b128 v[76:79], v8 offset:3072
  ds_read_b128 v[80:83], v8 offset:4096
  ds_read_b128 v[84:87], v8 offset:5120
  ds_read_b128 v[88:91], v8 offset:6144
  ds_read_b128 v[92:95], v8 offset:7168
  v_mov_b32 v9, 2
  s_waitcnt lgkmcnt(0)
  ds_write_b32 v6, v9
  v_and_b32 v10, 31, v1
  v_lshlrev_b32 v10, 7, v10
  s_lshr_b32 s79, s84, 4
  s_lshl_b32 s79, s79, 12
  s_add_u32 s79, s79, 0x0
  buffer_load_dword v11, v10, s[56:59], s79 offen sc1
  s_mov_b32 s78, 0
  v_mov_b32 v16, 0xc0135761
  v_mov_b32 v18, 0xbdd2d3e8
  s_lshl_b32 s10, s6, 1
  s_lshr_b32 s11, s77, 1
  s_add_u32 s10, s10, s11
  s_and_b32 s11, s77, 1
  s_lshl_b32 s11, s11, 1
  s_add_u32 s11, s11, 1
  s_mul_i32 s12, s10, 48
  s_lshl_b32 s13, s7, 2
  s_add_u32 s12, s12, s13
  s_lshl_b32 s12, s12, 2
  s_add_u32 s12, s12, s11
  s_lshl_b32 s12, s12, 10
  s_add_u32 s12, s12, 0x900000
  s_lshl_b32 s10, s6, 4
  s_add_u32 s10, s10, s7
  s_lshl_b32 s10, s10, 7
  s_add_u32 s93, s10, 0x40000
  v_mov_b32 v17, v16
  v_mov_b32 v19, v18
  v_mov_b32 v20, 1.0
  v_mov_b32 v21, 1.0
  v_pk_mul_f32 v[24:25], v[64:65], v[64:65]
  v_pk_mul_f32 v[26:27], v[66:67], v[66:67]
  v_pk_mul_f32 v[28:29], v[68:69], v[68:69]
  v_pk_mul_f32 v[30:31], v[70:71], v[70:71]
  v_pk_fma_f32 v[24:25], v[24:25], v[18:19], v[16:17]
  v_pk_fma_f32 v[26:27], v[26:27], v[18:19], v[16:17]
  v_pk_fma_f32 v[28:29], v[28:29], v[18:19], v[16:17]
  v_pk_fma_f32 v[30:31], v[30:31], v[18:19], v[16:17]
  v_pk_mul_f32 v[24:25], v[24:25], v[64:65]
  v_pk_mul_f32 v[26:27], v[26:27], v[66:67]
  v_pk_mul_f32 v[28:29], v[28:29], v[68:69]
  v_pk_mul_f32 v[30:31], v[30:31], v[70:71]
  v_exp_f32 v24, v24
  v_exp_f32 v25, v25
  v_exp_f32 v26, v26
  v_exp_f32 v27, v27
  v_exp_f32 v28, v28
  v_exp_f32 v29, v29
  v_exp_f32 v30, v30
  v_exp_f32 v31, v31
  v_pk_add_f32 v[24:25], v[24:25], v[20:21]
  v_pk_add_f32 v[26:27], v[26:27], v[20:21]
  v_pk_add_f32 v[28:29], v[28:29], v[20:21]
  v_pk_add_f32 v[30:31], v[30:31], v[20:21]
  v_rcp_f32 v24, v24
  v_rcp_f32 v25, v25
  v_rcp_f32 v26, v26
  v_rcp_f32 v27, v27
  v_rcp_f32 v28, v28
  v_rcp_f32 v29, v29
  v_rcp_f32 v30, v30
  v_rcp_f32 v31, v31
  v_pk_mul_f32 v[24:25], v[24:25], v[64:65]
  v_pk_mul_f32 v[26:27], v[26:27], v[66:67]
  v_pk_mul_f32 v[28:29], v[28:29], v[68:69]
  v_pk_mul_f32 v[30:31], v[30:31], v[70:71]
  v_cvt_pk_bf16_f32 v40, v24, v25
  v_cvt_pk_bf16_f32 v41, v26, v27
  v_cvt_pk_bf16_f32 v42, v28, v29
  v_cvt_pk_bf16_f32 v43, v30, v31
  buffer_store_dwordx4 v[40:43], v4, s[56:59], s12 offen sc1
  s_add_u32 s12, s12, 4096
  v_pk_mul_f32 v[24:25], v[72:73], v[72:73]
  v_pk_mul_f32 v[26:27], v[74:75], v[74:75]
  v_pk_mul_f32 v[28:29], v[76:77], v[76:77]
  v_pk_mul_f32 v[30:31], v[78:79], v[78:79]
  v_pk_fma_f32 v[24:25], v[24:25], v[18:19], v[16:17]
  v_pk_fma_f32 v[26:27], v[26:27], v[18:19], v[16:17]
  v_pk_fma_f32 v[28:29], v[28:29], v[18:19], v[16:17]
  v_pk_fma_f32 v[30:31], v[30:31], v[18:19], v[16:17]
  v_pk_mul_f32 v[24:25], v[24:25], v[72:73]
  v_pk_mul_f32 v[26:27], v[26:27], v[74:75]
  v_pk_mul_f32 v[28:29], v[28:29], v[76:77]
  v_pk_mul_f32 v[30:31], v[30:31], v[78:79]
  v_exp_f32 v24, v24
  v_exp_f32 v25, v25
  v_exp_f32 v26, v26
  v_exp_f32 v27, v27
  v_exp_f32 v28, v28
  v_exp_f32 v29, v29
  v_exp_f32 v30, v30
  v_exp_f32 v31, v31
  v_pk_add_f32 v[24:25], v[24:25], v[20:21]
  v_pk_add_f32 v[26:27], v[26:27], v[20:21]
  v_pk_add_f32 v[28:29], v[28:29], v[20:21]
  v_pk_add_f32 v[30:31], v[30:31], v[20:21]
  v_rcp_f32 v24, v24
  v_rcp_f32 v25, v25
  v_rcp_f32 v26, v26
  v_rcp_f32 v27, v27
  v_rcp_f32 v28, v28
  v_rcp_f32 v29, v29
  v_rcp_f32 v30, v30
  v_rcp_f32 v31, v31
  v_pk_mul_f32 v[24:25], v[24:25], v[72:73]
  v_pk_mul_f32 v[26:27], v[26:27], v[74:75]
  v_pk_mul_f32 v[28:29], v[28:29], v[76:77]
  v_pk_mul_f32 v[30:31], v[30:31], v[78:79]
  v_cvt_pk_bf16_f32 v44, v24, v25
  v_cvt_pk_bf16_f32 v45, v26, v27
  v_cvt_pk_bf16_f32 v46, v28, v29
  v_cvt_pk_bf16_f32 v47, v30, v31
  buffer_store_dwordx4 v[44:47], v4, s[56:59], s12 offen sc1
  s_add_u32 s12, s12, 4096
  s_and_b32 s10, s3, 1
  s_cmp_eq_u32 s10, 0
  s_cbranch_scc1 L_noexr
  s_waitcnt vmcnt(2)
  v_cmp_ne_u32 vcc, v11, v5
  s_nop 0
  s_cbranch_vccnz L_noexr
  s_lshl_b32 s10, s84, 12
  s_add_u32 s10, s10, 0x100000
  buffer_load_dwordx4 v[96:99], v4, s[56:59], s10 offen offset:0 sc1
  buffer_load_dwordx4 v[100:103], v4, s[56:59], s10 offen offset:1024 sc1
  buffer_load_dwordx4 v[104:107], v4, s[56:59], s10 offen offset:2048 sc1
  buffer_load_dwordx4 v[108:111], v4, s[56:59], s10 offen offset:3072 sc1
  s_mov_b32 s78, 1
L_noexr:
  v_pk_mul_f32 v[24:25], v[80:81], v[80:81]
  v_pk_mul_f32 v[26:27], v[82:83], v[82:83]
  v_pk_mul_f32 v[28:29], v[84:85], v[84:85]
  v_pk_mul_f32 v[30:31], v[86:87], v[86:87]
  v_pk_fma_f32 v[24:25], v[24:25], v[18:19], v[16:17]
  v_pk_fma_f32 v[26:27], v[26:27], v[18:19], v[16:17]
  v_pk_fma_f32 v[28:29], v[28:29], v[18:19], v[16:17]
  v_pk_fma_f32 v[30:31], v[30:31], v[18:19], v[16:17]
  v_pk_mul_f32 v[24:25], v[24:25], v[80:81]
  v_pk_mul_f32 v[26:27], v[26:27], v[82:83]
  v_pk_mul_f32 v[28:29], v[28:29], v[84:85]
  v_pk_mul_f32 v[30:31], v[30:31], v[86:87]
  v_exp_f32 v24, v24
  v_exp_f32 v25, v25
  v_exp_f32 v26, v26
  v_exp_f32 v27, v27
  v_exp_f32 v28, v28
  v_exp_f32 v29, v29
  v_exp_f32 v30, v30
  v_exp_f32 v31, v31
  v_pk_add_f32 v[24:25], v[24:25], v[20:21]
  v_pk_add_f32 v[26:27], v[26:27], v[20:21]
  v_pk_add_f32 v[28:29], v[28:29], v[20:21]
  v_pk_add_f32 v[30:31], v[30:31], v[20:21]
  v_rcp_f32 v24, v24
  v_rcp_f32 v25, v25
  v_rcp_f32 v26, v26
  v_rcp_f32 v27, v27
  v_rcp_f32 v28, v28
  v_rcp_f32 v29, v29
  v_rcp_f32 v30, v30
  v_rcp_f32 v31, v31
  v_pk_mul_f32 v[24:25], v[24:25], v[80:81]
  v_pk_mul_f32 v[26:27], v[26:27], v[82:83]
  v_pk_mul_f32 v[28:29], v[28:29], v[84:85]
  v_pk_mul_f32 v[30:31], v[30:31], v[86:87]
  v_cvt_pk_bf16_f32 v48, v24, v25
  v_cvt_pk_bf16_f32 v49, v26, v27
  v_cvt_pk_bf16_f32 v50, v28, v29
  v_cvt_pk_bf16_f32 v51, v30, v31
  buffer_store_dwordx4 v[48:51], v4, s[56:59], s12 offen sc1
  s_add_u32 s12, s12, 4096
  v_pk_mul_f32 v[24:25], v[88:89], v[88:89]
  v_pk_mul_f32 v[26:27], v[90:91], v[90:91]
  v_pk_mul_f32 v[28:29], v[92:93], v[92:93]
  v_pk_mul_f32 v[30:31], v[94:95], v[94:95]
  v_pk_fma_f32 v[24:25], v[24:25], v[18:19], v[16:17]
  v_pk_fma_f32 v[26:27], v[26:27], v[18:19], v[16:17]
  v_pk_fma_f32 v[28:29], v[28:29], v[18:19], v[16:17]
  v_pk_fma_f32 v[30:31], v[30:31], v[18:19], v[16:17]
  v_pk_mul_f32 v[24:25], v[24:25], v[88:89]
  v_pk_mul_f32 v[26:27], v[26:27], v[90:91]
  v_pk_mul_f32 v[28:29], v[28:29], v[92:93]
  v_pk_mul_f32 v[30:31], v[30:31], v[94:95]
  v_exp_f32 v24, v24
  v_exp_f32 v25, v25
  v_exp_f32 v26, v26
  v_exp_f32 v27, v27
  v_exp_f32 v28, v28
  v_exp_f32 v29, v29
  v_exp_f32 v30, v30
  v_exp_f32 v31, v31
  v_pk_add_f32 v[24:25], v[24:25], v[20:21]
  v_pk_add_f32 v[26:27], v[26:27], v[20:21]
  v_pk_add_f32 v[28:29], v[28:29], v[20:21]
  v_pk_add_f32 v[30:31], v[30:31], v[20:21]
  v_rcp_f32 v24, v24
  v_rcp_f32 v25, v25
  v_rcp_f32 v26, v26
  v_rcp_f32 v27, v27
  v_rcp_f32 v28, v28
  v_rcp_f32 v29, v29
  v_rcp_f32 v30, v30
  v_rcp_f32 v31, v31
  v_pk_mul_f32 v[24:25], v[24:25], v[88:89]
  v_pk_mul_f32 v[26:27], v[26:27], v[90:91]
  v_pk_mul_f32 v[28:29], v[28:29], v[92:93]
  v_pk_mul_f32 v[30:31], v[30:31], v[94:95]
  v_cvt_pk_bf16_f32 v52, v24, v25
  v_cvt_pk_bf16_f32 v53, v26, v27
  v_cvt_pk_bf16_f32 v54, v28, v29
  v_cvt_pk_bf16_f32 v55, v30, v31
  buffer_store_dwordx4 v[52:55], v4, s[56:59], s12 offen sc1
  s_waitcnt vmcnt(0)
  v_mov_b32 v6, 157188
  v_mov_b32 v8, 1
  s_mov_b64 exec, 1
  ds_add_rtn_u32 v8, v6, v8
  s_waitcnt lgkmcnt(0)
  v_readfirstlane_b32 s10, v8
  s_mov_b64 exec, -1
  s_cmp_lg_u32 s10, 7
  s_cbranch_scc1 L_hp_5
  v_mov_b32 v6, 0
  s_mov_b64 exec, 1
  buffer_store_dword v5, v6, s[56:59], s93 offen sc1
  s_mov_b64 exec, -1
L_hp_5:
  s_cmp_ge_u32 s7, 8
  s_cbranch_scc1 L_nogs
  v_lshlrev_b32 v26, 16, v200
  v_and_b32 v27, 0xffff0000, v200
  v_lshlrev_b32 v28, 16, v220
  v_and_b32 v29, 0xffff0000, v220
  v_mul_f32 v24, v26, v28
  v_mul_f32 v25, v27, v29
  v_lshlrev_b32 v26, 16, v201
  v_and_b32 v27, 0xffff0000, v201
  v_lshlrev_b32 v28, 16, v221
  v_and_b32 v29, 0xffff0000, v221
  v_fma_f32 v24, v26, v28, v24
  v_fma_f32 v25, v27, v29, v25
  v_lshlrev_b32 v26, 16, v202
  v_and_b32 v27, 0xffff0000, v202
  v_lshlrev_b32 v28, 16, v222
  v_and_b32 v29, 0xffff0000, v222
  v_fma_f32 v24, v26, v28, v24
  v_fma_f32 v25, v27, v29, v25
  v_lshlrev_b32 v26, 16, v203
  v_and_b32 v27, 0xffff0000, v203
  v_lshlrev_b32 v28, 16, v223
  v_and_b32 v29, 0xffff0000, v223
  v_fma_f32 v24, v26, v28, v24
  v_fma_f32 v25, v27, v29, v25
  v_lshlrev_b32 v26, 16, v204
  v_and_b32 v27, 0xffff0000, v204
  v_lshlrev_b32 v28, 16, v224
  v_and_b32 v29, 0xffff0000, v224
  v_fma_f32 v24, v26, v28, v24
  v_fma_f32 v25, v27, v29, v25
  v_lshlrev_b32 v26, 16, v205
  v_and_b32 v27, 0xffff0000, v205
  v_lshlrev_b32 v28, 16, v225
  v_and_b32 v29, 0xffff0000, v225
  v_fma_f32 v24, v26, v28, v24
  v_fma_f32 v25, v27, v29, v25
  v_lshlrev_b32 v26, 16, v206
  v_and_b32 v27, 0xffff0000, v206
  v_lshlrev_b32 v28, 16, v226
  v_and_b32 v29, 0xffff0000, v226
  v_fma_f32 v24, v26, v28, v24
  v_fma_f32 v25, v27, v29, v25
  v_lshlrev_b32 v26, 16, v207
  v_and_b32 v27, 0xffff0000, v207
  v_lshlrev_b32 v28, 16, v227
  v_and_b32 v29, 0xffff0000, v227
  v_fma_f32 v24, v26, v28, v24
  v_fma_f32 v25, v27, v29, v25
  v_lshlrev_b32 v26, 16, v208
  v_and_b32 v27, 0xffff0000, v208
  v_lshlrev_b32 v28, 16, v228
  v_and_b32 v29, 0xffff0000, v228
  v_fma_f32 v24, v26, v28, v24
  v_fma_f32 v25, v27, v29, v25
  v_lshlrev_b32 v26, 16, v209
  v_and_b32 v27, 0xffff0000, v209
  v_lshlrev_b32 v28, 16, v229
  v_and_b32 v29, 0xffff0000, v229
  v_fma_f32 v24, v26, v28, v24
  v_fma_f32 v25, v27, v29, v25
  v_lshlrev_b32 v26, 16, v210
  v_and_b32 v27, 0xffff0000, v210
  v_lshlrev_b32 v28, 16, v230
  v_and_b32 v29, 0xffff0000, v230
  v_fma_f32 v24, v26, v28, v24
  v_fma_f32 v25, v27, v29, v25
  v_lshlrev_b32 v26, 16, v211
  v_and_b32 v27, 0xffff0000, v211
  v_lshlrev_b32 v28, 16, v231
  v_and_b32 v29, 0xffff0000, v231
  v_fma_f32 v24, v26, v28, v24
  v_fma_f32 v25, v27, v29, v25
  v_lshlrev_b32 v26, 16, v212
  v_and_b32 v27, 0xffff0000, v212
  v_lshlrev_b32 v28, 16, v232
  v_and_b32 v29, 0xffff0000, v232
  v_fma_f32 v24, v26, v28, v24
  v_fma_f32 v25, v27, v29, v25
  v_lshlrev_b32 v26, 16, v213
  v_and_b32 v27, 0xffff0000, v213
  v_lshlrev_b32 v28, 16, v233
  v_and_b32 v29, 0xffff0000, v233
  v_fma_f32 v24, v26, v28, v24
  v_fma_f32 v25, v27, v29, v25
  v_lshlrev_b32 v26, 16, v214
  v_and_b32 v27, 0xffff0000, v214
  v_lshlrev_b32 v28, 16, v234
  v_and_b32 v29, 0xffff0000, v234
  v_fma_f32 v24, v26, v28, v24
  v_fma_f32 v25, v27, v29, v25
  v_lshlrev_b32 v26, 16, v215
  v_and_b32 v27, 0xffff0000, v215
  v_lshlrev_b32 v28, 16, v235
  v_and_b32 v29, 0xffff0000, v235
  v_fma_f32 v24, v26, v28, v24
  v_fma_f32 v25, v27, v29, v25
  v_lshlrev_b32 v26, 16, v216
  v_and_b32 v27, 0xffff0000, v216
  v_lshlrev_b32 v28, 16, v236
  v_and_b32 v29, 0xffff0000, v236
  v_fma_f32 v24, v26, v28, v24
  v_fma_f32 v25, v27, v29, v25
  v_lshlrev_b32 v26, 16, v217
  v_and_b32 v27, 0xffff0000, v217
  v_lshlrev_b32 v28, 16, v237
  v_and_b32 v29, 0xffff0000, v237
  v_fma_f32 v24, v26, v28, v24
  v_fma_f32 v25, v27, v29, v25
  v_lshlrev_b32 v26, 16, v218
  v_and_b32 v27, 0xffff0000, v218
  v_lshlrev_b32 v28, 16, v238
  v_and_b32 v29, 0xffff0000, v238
  v_fma_f32 v24, v26, v28, v24
  v_fma_f32 v25, v27, v29, v25
  v_lshlrev_b32 v26, 16, v219
  v_and_b32 v27, 0xffff0000, v219
  v_lshlrev_b32 v28, 16, v239
  v_and_b32 v29, 0xffff0000, v239
  v_fma_f32 v24, v26, v28, v24
  v_fma_f32 v25, v27, v29, v25
  v_add_f32 v24, v24, v25
  ds_swizzle_b32 v30, v24 offset:1055
  s_waitcnt lgkmcnt(0)
  v_add_f32 v24, v24, v30
  ds_swizzle_b32 v30, v24 offset:2079
  s_waitcnt lgkmcnt(0)
  v_add_f32 v24, v24, v30
  ds_swizzle_b32 v30, v24 offset:4127
  s_waitcnt lgkmcnt(0)
  v_add_f32 v24, v24, v30
  ds_swizzle_b32 v30, v24 offset:8223
  s_waitcnt lgkmcnt(0)
  v_add_f32 v24, v24, v30
  v_cvt_pk_bf16_f32 v30, v24, v24
  v_lshlrev_b32 v24, 16, v30
  v_mul_f32 v24, 0xbfb8aa3b, v24
  v_exp_f32 v24, v24
  s_nop 0
  v_add_f32 v24, 1.0, v24
  v_rcp_f32 v24, v24
  s_nop 0
  v_cvt_pk_bf16_f32 v30, v24, v24
  v_lshlrev_b32 v32, 16, v30
  v_mov_b32 v33, v5
  s_mov_b32 s10, 0x70000
  s_mov_b32 s86, 0x10001
  s_mov_b32 s87, 0x10001
  s_mov_b64 exec, s[86:87]
  buffer_store_dwordx2 v[32:33], v34, s[56:59], s10 offen sc1
  s_mov_b64 exec, -1
L_nogs:
  s_sub_u32 s10, s3, 4
  s_cmp_eq_u32 s10, 0
  s_cselect_b32 s98, 104448, s98
  s_cmp_eq_u32 s10, 1
  s_cselect_b32 s98, 157696, s98
  s_cmp_eq_u32 s10, 2
  s_cselect_b32 s98, 114688, s98
  s_cmp_eq_u32 s10, 3
  s_cselect_b32 s98, 135936, s98
  v_and_b32 v14, 1, v1
  v_lshlrev_b32 v14, 3, v14
  v_add_u32 v14, 157300, v14
  s_mov_b32 s81, 2
  s_and_b32 s10, s3, 1
  s_cmp_eq_u32 s10, 0
  s_cbranch_scc1 L_cv6
  s_branch L_cv7
L_G:
  v_lshlrev_b32 v6, 2, v1
  v_add_u32 v6, 157184, v6
  v_mov_b32 v7, 0
  ds_write_b32 v6, v7
  s_waitcnt lgkmcnt(0)
  s_mov_b32 s56, s44
  s_mov_b32 s57, s45
  s_mov_b32 s58, 0x1000000
  s_mov_b32 s59, 0x20000
  s_add_u32 s10, s2, s3
  s_cmp_lg_u32 s10, 0
  s_cbranch_scc1 L_nonce_skip
  s_memrealtime s[88:89]
  s_waitcnt lgkmcnt(0)
  s_mul_i32 s10, s88, 0x9E3779B1
  s_xor_b32 s10, s10, s89
  s_or_b32 s10, s10, 1
  v_mov_b32 v16, s10
  v_mov_b32 v17, 0
  global_store_dword v17, v16, s[42:43] sc1
L_nonce_skip:
  v_lshlrev_b32 v6, 3, v3
  s_lshl_b32 s10, s7, 8
  s_add_u32 s12, s32, s10
  s_addc_u32 s13, s33, 0
  global_load_dwordx2 v[208:209], v6, s[12:13] offset:0
  global_load_dwordx2 v[210:211], v6, s[12:13] offset:32
  global_load_dwordx2 v[212:213], v6, s[12:13] offset:64
  global_load_dwordx2 v[214:215], v6, s[12:13] offset:96
  global_load_dwordx2 v[216:217], v6, s[12:13] offset:128
  global_load_dwordx2 v[218:219], v6, s[12:13] offset:160
  global_load_dwordx2 v[220:221], v6, s[12:13] offset:192
  global_load_dwordx2 v[222:223], v6, s[12:13] offset:224
  s_and_b32 s10, s5, 7
  s_lshl_b32 s10, s10, 2
  s_add_u32 s10, s10, s77
  s_min_u32 s10, s10, 20
  s_lshl_b32 s10, s10, 10
  v_add_u32 v6, s10, v4
  global_load_dwordx4 v[244:247], v6, s[94:95]
  s_mul_i32 s10, s4, 24
  s_add_u32 s10, s10, s5
  s_lshl_b32 s10, s10, 13
  s_lshl_b32 s11, s77, 11
  s_add_u32 s10, s10, s11
  s_add_u32 s10, s10, 1048576
  v_add_u32 v20, s10, v4
  s_lshl_b32 s10, s77, 5
  v_add_u32 v6, s10, v2
  v_lshlrev_b32 v6, 7, v6
  v_lshrrev_b32 v7, 1, v2
  v_xor_b32 v7, v7, v3
  v_lshlrev_b32 v7, 4, v7
  v_add_u32 v8, v6, v7
  v_xor_b32 v9, 64, v8
  v_mul_u32_u24 v6, 2080, v3
  v_bfe_u32 v7, v1, 2, 2
  v_lshl_add_u32 v6, v7, 7, v6
  v_and_b32 v7, 3, v1
  v_lshl_add_u32 v6, v7, 3, v6
  v_add_u32 v6, 0x4000, v6
  v_bfe_u32 v7, v1, 3, 1
  v_lshlrev_b32 v7, 6, v7
  v_add_u32 v10, v6, v7
  v_sub_u32 v11, v6, v7
  v_mov_b32 v136, 0
  v_mov_b32 v137, 0
  v_mov_b32 v138, 0
  v_mov_b32 v139, 0
  v_mov_b32 v140, 0
  v_mov_b32 v141, 0
  v_mov_b32 v142, 0
  v_mov_b32 v143, 0
  v_mov_b32 v176, 0
  v_mov_b32 v177, 0
  v_mov_b32 v178, 0
  v_mov_b32 v179, 0
  v_mov_b32 v180, 0
  v_mov_b32 v181, 0
  v_mov_b32 v182, 0
  v_mov_b32 v183, 0
  v_mov_b32 v184, 0
  v_mov_b32 v185, 0
  v_mov_b32 v186, 0
  v_mov_b32 v187, 0
  v_mov_b32 v188, 0
  v_mov_b32 v189, 0
  v_mov_b32 v190, 0
  v_mov_b32 v191, 0
  v_mov_b32 v192, 0
  v_mov_b32 v193, 0
  v_mov_b32 v194, 0
  v_mov_b32 v195, 0
  v_mov_b32 v196, 0
  v_mov_b32 v197, 0
  v_mov_b32 v198, 0
  v_mov_b32 v199, 0
  v_mov_b32 v200, 0
  v_mov_b32 v201, 0
  v_mov_b32 v202, 0
  v_mov_b32 v203, 0
  v_mov_b32 v204, 0
  v_mov_b32 v205, 0
  v_mov_b32 v206, 0
  v_mov_b32 v207, 0
  s_mov_b32 s80, 0
  s_mov_b32 s81, 10
  v_mov_b32 v12, v8
  v_mov_b32 v13, v9
  v_mov_b32 v14, v10
  v_mov_b32 v15, v11
  s_lshl_b32 s10, s77, 2
  s_add_u32 s10, s10, 157248
  v_mov_b32 v18, s10
  s_waitcnt vmcnt(1)
  v_lshlrev_b32 v64, 16, v208
  v_and_b32 v65, 0xffff0000, v208
  v_lshlrev_b32 v66, 16, v209
  v_and_b32 v67, 0xffff0000, v209
  v_lshlrev_b32 v68, 16, v210
  v_and_b32 v69, 0xffff0000, v210
  v_lshlrev_b32 v70, 16, v211
  v_and_b32 v71, 0xffff0000, v211
  v_lshlrev_b32 v72, 16, v212
  v_and_b32 v73, 0xffff0000, v212
  v_lshlrev_b32 v74, 16, v213
  v_and_b32 v75, 0xffff0000, v213
  v_lshlrev_b32 v76, 16, v214
  v_and_b32 v77, 0xffff0000, v214
  v_lshlrev_b32 v78, 16, v215
  v_and_b32 v79, 0xffff0000, v215
  v_lshlrev_b32 v80, 16, v216
  v_and_b32 v81, 0xffff0000, v216
  v_lshlrev_b32 v82, 16, v217
  v_and_b32 v83, 0xffff0000, v217
  v_lshlrev_b32 v84, 16, v218
  v_and_b32 v85, 0xffff0000, v218
  v_lshlrev_b32 v86, 16, v219
  v_and_b32 v87, 0xffff0000, v219
  v_lshlrev_b32 v88, 16, v220
  v_and_b32 v89, 0xffff0000, v220
  v_lshlrev_b32 v90, 16, v221
  v_and_b32 v91, 0xffff0000, v221
  v_lshlrev_b32 v92, 16, v222
  v_and_b32 v93, 0xffff0000, v222
  v_lshlrev_b32 v94, 16, v223
  v_and_b32 v95, 0xffff0000, v223
  v_lshlrev_b32 v96, 16, v208
  v_and_b32 v97, 0xffff0000, v208
  v_lshlrev_b32 v98, 16, v209
  v_and_b32 v99, 0xffff0000, v209
  v_lshlrev_b32 v100, 16, v210
  v_and_b32 v101, 0xffff0000, v210
  v_lshlrev_b32 v102, 16, v211
  v_and_b32 v103, 0xffff0000, v211
  v_lshlrev_b32 v104, 16, v212
  v_and_b32 v105, 0xffff0000, v212
  v_lshlrev_b32 v106, 16, v213
  v_and_b32 v107, 0xffff0000, v213
  v_lshlrev_b32 v108, 16, v214
  v_and_b32 v109, 0xffff0000, v214
  v_lshlrev_b32 v110, 16, v215
  v_and_b32 v111, 0xffff0000, v215
  v_lshlrev_b32 v112, 16, v216
  v_and_b32 v113, 0xffff0000, v216
  v_lshlrev_b32 v114, 16, v217
  v_and_b32 v115, 0xffff0000, v217
  v_lshlrev_b32 v116, 16, v218
  v_and_b32 v117, 0xffff0000, v218
  v_lshlrev_b32 v118, 16, v219
  v_and_b32 v119, 0xffff0000, v219
  v_lshlrev_b32 v120, 16, v220
  v_and_b32 v121, 0xffff0000, v220
  v_lshlrev_b32 v122, 16, v221
  v_and_b32 v123, 0xffff0000, v221
  v_lshlrev_b32 v124, 16, v222
  v_and_b32 v125, 0xffff0000, v222
  v_lshlrev_b32 v126, 16, v223
  v_and_b32 v127, 0xffff0000, v223
L_g1:
  s_barrier
  v_mfma_f32_16x16x32_bf16 v[64:67], v[176:179], v[136:139], v[64:67]
  ds_read_b128 v[128:131], v12 offset:0
  ds_read_b128 v[132:135], v12 offset:2048
  v_mfma_f32_16x16x32_bf16 v[96:99], v[176:179], v[140:143], v[96:99]
  ds_read_b64_tr_b16 v[144:145], v14 offset:0
  ds_read_b64_tr_b16 v[146:147], v14 offset:1024
  v_mfma_f32_16x16x32_bf16 v[68:71], v[180:183], v[136:139], v[68:71]
  ds_read_b64_tr_b16 v[148:149], v14 offset:32
  v_mfma_f32_16x16x32_bf16 v[100:103], v[180:183], v[140:143], v[100:103]
  ds_read_b64_tr_b16 v[150:151], v14 offset:1056
  v_mfma_f32_16x16x32_bf16 v[72:75], v[184:187], v[136:139], v[72:75]
  ds_read_b64_tr_b16 v[152:153], v15 offset:64
  v_mfma_f32_16x16x32_bf16 v[104:107], v[184:187], v[140:143], v[104:107]
  ds_read_b64_tr_b16 v[154:155], v15 offset:1088
  v_mfma_f32_16x16x32_bf16 v[76:79], v[188:191], v[136:139], v[76:79]
  ds_read_b64_tr_b16 v[156:157], v15 offset:96
  v_mfma_f32_16x16x32_bf16 v[108:111], v[188:191], v[140:143], v[108:111]
  ds_read_b64_tr_b16 v[158:159], v15 offset:1120
  v_mfma_f32_16x16x32_bf16 v[80:83], v[192:195], v[136:139], v[80:83]
  ds_read_b64_tr_b16 v[160:161], v14 offset:512
  v_mfma_f32_16x16x32_bf16 v[112:115], v[192:195], v[140:143], v[112:115]
  ds_read_b64_tr_b16 v[162:163], v14 offset:1536
  v_mfma_f32_16x16x32_bf16 v[84:87], v[196:199], v[136:139], v[84:87]
  ds_read_b64_tr_b16 v[164:165], v14 offset:544
  v_mfma_f32_16x16x32_bf16 v[116:119], v[196:199], v[140:143], v[116:119]
  ds_read_b64_tr_b16 v[166:167], v14 offset:1568
  v_mfma_f32_16x16x32_bf16 v[88:91], v[200:203], v[136:139], v[88:91]
  ds_read_b64_tr_b16 v[168:169], v15 offset:576
  v_mfma_f32_16x16x32_bf16 v[120:123], v[200:203], v[140:143], v[120:123]
  ds_read_b64_tr_b16 v[170:171], v15 offset:1600
  v_mfma_f32_16x16x32_bf16 v[92:95], v[204:207], v[136:139], v[92:95]
  ds_read_b64_tr_b16 v[172:173], v15 offset:608
  v_mfma_f32_16x16x32_bf16 v[124:127], v[204:207], v[140:143], v[124:127]
  ds_read_b64_tr_b16 v[174:175], v15 offset:1632
  s_cmp_lg_u32 s81, 5
  s_cbranch_scc1 L_g1_nw
  global_load_dwordx4 v[232:235], v20, s[24:25]
  global_load_dwordx4 v[236:239], v20, s[24:25] offset:1024
L_g1_nw:
  s_waitcnt lgkmcnt(14)
  v_mfma_f32_16x16x32_bf16 v[64:67], v[144:147], v[128:131], v[64:67]
  v_mfma_f32_16x16x32_bf16 v[96:99], v[144:147], v[132:135], v[96:99]
  ds_read_b128 v[136:139], v13 offset:0
  ds_read_b128 v[140:143], v13 offset:2048
  s_waitcnt lgkmcnt(14)
  v_mfma_f32_16x16x32_bf16 v[68:71], v[148:151], v[128:131], v[68:71]
  ds_read_b64_tr_b16 v[176:177], v14 offset:8320
  v_mfma_f32_16x16x32_bf16 v[100:103], v[148:151], v[132:135], v[100:103]
  ds_read_b64_tr_b16 v[178:179], v14 offset:9344
  ds_read_b64_tr_b16 v[180:181], v14 offset:8352
  s_waitcnt lgkmcnt(14)
  v_mfma_f32_16x16x32_bf16 v[72:75], v[152:155], v[128:131], v[72:75]
  ds_read_b64_tr_b16 v[182:183], v14 offset:9376
  v_mfma_f32_16x16x32_bf16 v[104:107], v[152:155], v[132:135], v[104:107]
  ds_read_b64_tr_b16 v[184:185], v15 offset:8384
  ds_read_b64_tr_b16 v[186:187], v15 offset:9408
  s_waitcnt lgkmcnt(14)
  v_mfma_f32_16x16x32_bf16 v[76:79], v[156:159], v[128:131], v[76:79]
  ds_read_b64_tr_b16 v[188:189], v15 offset:8416
  v_mfma_f32_16x16x32_bf16 v[108:111], v[156:159], v[132:135], v[108:111]
  ds_read_b64_tr_b16 v[190:191], v15 offset:9440
  ds_read_b64_tr_b16 v[192:193], v14 offset:8832
  s_waitcnt lgkmcnt(14)
  v_mfma_f32_16x16x32_bf16 v[80:83], v[160:163], v[128:131], v[80:83]
  ds_read_b64_tr_b16 v[194:195], v14 offset:9856
  v_mfma_f32_16x16x32_bf16 v[112:115], v[160:163], v[132:135], v[112:115]
  ds_read_b64_tr_b16 v[196:197], v14 offset:8864
  ds_read_b64_tr_b16 v[198:199], v14 offset:9888
  s_waitcnt lgkmcnt(14)
  v_mfma_f32_16x16x32_bf16 v[84:87], v[164:167], v[128:131], v[84:87]
  ds_read_b64_tr_b16 v[200:201], v15 offset:8896
  ds_read_b64_tr_b16 v[202:203], v15 offset:9920
  v_mfma_f32_16x16x32_bf16 v[116:119], v[164:167], v[132:135], v[116:119]
  ds_read_b64_tr_b16 v[204:205], v15 offset:8928
  ds_read_b64_tr_b16 v[206:207], v15 offset:9952
  s_waitcnt lgkmcnt(14)
  v_mfma_f32_16x16x32_bf16 v[88:91], v[168:171], v[128:131], v[88:91]
  v_mfma_f32_16x16x32_bf16 v[120:123], v[168:171], v[132:135], v[120:123]
  s_waitcnt lgkmcnt(14)
  v_mfma_f32_16x16x32_bf16 v[92:95], v[172:175], v[128:131], v[92:95]
  v_mfma_f32_16x16x32_bf16 v[124:127], v[172:175], v[132:135], v[124:127]
  s_add_u32 s80, s80, 33024
  s_cmp_eq_u32 s80, 132096
  s_cselect_b32 s80, 0, s80
  v_add_u32 v12, s80, v8
  v_add_u32 v13, s80, v9
  v_add_u32 v14, s80, v10
  v_add_u32 v15, s80, v11
  s_sub_u32 s81, s81, 1
  s_cmp_lg_u32 s81, 0
  s_waitcnt lgkmcnt(0)
  s_cbranch_scc1 L_g1
  v_mfma_f32_16x16x32_bf16 v[96:99], v[176:179], v[140:143], v[96:99]
  v_mfma_f32_16x16x32_bf16 v[100:103], v[180:183], v[140:143], v[100:103]
  v_mfma_f32_16x16x32_bf16 v[104:107], v[184:187], v[140:143], v[104:107]
  v_mfma_f32_16x16x32_bf16 v[108:111], v[188:191], v[140:143], v[108:111]
  v_mfma_f32_16x16x32_bf16 v[112:115], v[192:195], v[140:143], v[112:115]
  v_mfma_f32_16x16x32_bf16 v[116:119], v[196:199], v[140:143], v[116:119]
  v_mfma_f32_16x16x32_bf16 v[120:123], v[200:203], v[140:143], v[120:123]
  v_mfma_f32_16x16x32_bf16 v[124:127], v[204:207], v[140:143], v[124:127]
  v_mfma_f32_16x16x32_bf16 v[64:67], v[176:179], v[136:139], v[64:67]
  v_mfma_f32_16x16x32_bf16 v[68:71], v[180:183], v[136:139], v[68:71]
  v_mfma_f32_16x16x32_bf16 v[72:75], v[184:187], v[136:139], v[72:75]
  v_mfma_f32_16x16x32_bf16 v[76:79], v[188:191], v[136:139], v[76:79]
  v_mfma_f32_16x16x32_bf16 v[80:83], v[192:195], v[136:139], v[80:83]
  v_mfma_f32_16x16x32_bf16 v[84:87], v[196:199], v[136:139], v[84:87]
  v_mfma_f32_16x16x32_bf16 v[88:91], v[200:203], v[136:139], v[88:91]
  v_mfma_f32_16x16x32_bf16 v[92:95], v[204:207], v[136:139], v[92:95]
  v_mov_b32 v7, 157184
  ds_read_b32 v5, v7
  s_lshl_b32 s10, s77, 13
  s_add_u32 s10, s10, 66048
  v_add_u32 v8, s10, v4
  ds_write_b128 v8, v[96:99] offset:0
  ds_write_b128 v8, v[100:103] offset:1024
  ds_write_b128 v8, v[104:107] offset:2048
  ds_write_b128 v8, v[108:111] offset:3072
  ds_write_b128 v8, v[112:115] offset:4096
  ds_write_b128 v8, v[116:119] offset:5120
  ds_write_b128 v8, v[120:123] offset:6144
  ds_write_b128 v8, v[124:127] offset:7168
  v_mov_b32 v6, 1
  ds_write_b32 v18, v6
  v_and_b32 v14, 1, v1
  v_lshlrev_b32 v14, 3, v14
  v_add_u32 v14, 157300, v14
  v_min_u32 v10, 47, v1
  v_lshlrev_b32 v10, 7, v10
  s_lshl_b32 s15, s9, 13
  s_add_u32 s15, s15, 0x30000
  buffer_load_dword v11, v10, s[56:59], s15 offen sc1
  v_mov_b32 v16, 0xc0135761
  v_mov_b32 v18, 0xbdd2d3e8
  s_lshl_b32 s10, s6, 1
  s_lshr_b32 s11, s77, 1
  s_add_u32 s10, s10, s11
  s_and_b32 s11, s77, 1
  s_lshl_b32 s11, s11, 1
  s_add_u32 s11, s11, 0
  s_mul_i32 s12, s10, 48
  s_lshl_b32 s13, s7, 2
  s_add_u32 s12, s12, s13
  s_lshl_b32 s12, s12, 2
  s_add_u32 s12, s12, s11
  s_lshl_b32 s12, s12, 10
  s_add_u32 s12, s12, 0x900000
  s_lshl_b32 s10, s6, 4
  s_add_u32 s10, s10, s7
  s_lshl_b32 s10, s10, 7
  s_add_u32 s93, s10, 0x40000
  v_mov_b32 v17, v16
  v_mov_b32 v19, v18
  v_mov_b32 v20, 1.0
  v_mov_b32 v21, 1.0
  v_pk_mul_f32 v[24:25], v[64:65], v[64:65]
  v_pk_mul_f32 v[26:27], v[66:67], v[66:67]
  v_pk_mul_f32 v[28:29], v[68:69], v[68:69]
  v_pk_mul_f32 v[30:31], v[70:71], v[70:71]
  v_pk_fma_f32 v[24:25], v[24:25], v[18:19], v[16:17]
  v_pk_fma_f32 v[26:27], v[26:27], v[18:19], v[16:17]
  v_pk_fma_f32 v[28:29], v[28:29], v[18:19], v[16:17]
  v_pk_fma_f32 v[30:31], v[30:31], v[18:19], v[16:17]
  v_pk_mul_f32 v[24:25], v[24:25], v[64:65]
  v_pk_mul_f32 v[26:27], v[26:27], v[66:67]
  v_pk_mul_f32 v[28:29], v[28:29], v[68:69]
  v_pk_mul_f32 v[30:31], v[30:31], v[70:71]
  v_exp_f32 v24, v24
  v_exp_f32 v25, v25
  v_exp_f32 v26, v26
  v_exp_f32 v27, v27
  v_exp_f32 v28, v28
  v_exp_f32 v29, v29
  v_exp_f32 v30, v30
  v_exp_f32 v31, v31
  v_pk_add_f32 v[24:25], v[24:25], v[20:21]
  v_pk_add_f32 v[26:27], v[26:27], v[20:21]
  v_pk_add_f32 v[28:29], v[28:29], v[20:21]
  v_pk_add_f32 v[30:31], v[30:31], v[20:21]
  v_rcp_f32 v24, v24
  v_rcp_f32 v25, v25
  v_rcp_f32 v26, v26
  v_rcp_f32 v27, v27
  v_rcp_f32 v28, v28
  v_rcp_f32 v29, v29
  v_rcp_f32 v30, v30
  v_rcp_f32 v31, v31
  v_pk_mul_f32 v[24:25], v[24:25], v[64:65]
  v_pk_mul_f32 v[26:27], v[26:27], v[66:67]
  v_pk_mul_f32 v[28:29], v[28:29], v[68:69]
  v_pk_mul_f32 v[30:31], v[30:31], v[70:71]
  v_cvt_pk_bf16_f32 v40, v24, v25
  v_cvt_pk_bf16_f32 v41, v26, v27
  v_cvt_pk_bf16_f32 v42, v28, v29
  v_cvt_pk_bf16_f32 v43, v30, v31
  buffer_store_dwordx4 v[40:43], v4, s[56:59], s12 offen sc1
  s_add_u32 s12, s12, 4096
  v_pk_mul_f32 v[24:25], v[72:73], v[72:73]
  v_pk_mul_f32 v[26:27], v[74:75], v[74:75]
  v_pk_mul_f32 v[28:29], v[76:77], v[76:77]
  v_pk_mul_f32 v[30:31], v[78:79], v[78:79]
  v_pk_fma_f32 v[24:25], v[24:25], v[18:19], v[16:17]
  v_pk_fma_f32 v[26:27], v[26:27], v[18:19], v[16:17]
  v_pk_fma_f32 v[28:29], v[28:29], v[18:19], v[16:17]
  v_pk_fma_f32 v[30:31], v[30:31], v[18:19], v[16:17]
  v_pk_mul_f32 v[24:25], v[24:25], v[72:73]
  v_pk_mul_f32 v[26:27], v[26:27], v[74:75]
  v_pk_mul_f32 v[28:29], v[28:29], v[76:77]
  v_pk_mul_f32 v[30:31], v[30:31], v[78:79]
  v_exp_f32 v24, v24
  v_exp_f32 v25, v25
  v_exp_f32 v26, v26
  v_exp_f32 v27, v27
  v_exp_f32 v28, v28
  v_exp_f32 v29, v29
  v_exp_f32 v30, v30
  v_exp_f32 v31, v31
  v_pk_add_f32 v[24:25], v[24:25], v[20:21]
  v_pk_add_f32 v[26:27], v[26:27], v[20:21]
  v_pk_add_f32 v[28:29], v[28:29], v[20:21]
  v_pk_add_f32 v[30:31], v[30:31], v[20:21]
  v_rcp_f32 v24, v24
  v_rcp_f32 v25, v25
  v_rcp_f32 v26, v26
  v_rcp_f32 v27, v27
  v_rcp_f32 v28, v28
  v_rcp_f32 v29, v29
  v_rcp_f32 v30, v30
  v_rcp_f32 v31, v31
  v_pk_mul_f32 v[24:25], v[24:25], v[72:73]
  v_pk_mul_f32 v[26:27], v[26:27], v[74:75]
  v_pk_mul_f32 v[28:29], v[28:29], v[76:77]
  v_pk_mul_f32 v[30:31], v[30:31], v[78:79]
  v_cvt_pk_bf16_f32 v44, v24, v25
  v_cvt_pk_bf16_f32 v45, v26, v27
  v_cvt_pk_bf16_f32 v46, v28, v29
  v_cvt_pk_bf16_f32 v47, v30, v31
  buffer_store_dwordx4 v[44:47], v4, s[56:59], s12 offen sc1
  s_add_u32 s12, s12, 4096
  v_pk_mul_f32 v[24:25], v[80:81], v[80:81]
  v_pk_mul_f32 v[26:27], v[82:83], v[82:83]
  v_pk_mul_f32 v[28:29], v[84:85], v[84:85]
  v_pk_mul_f32 v[30:31], v[86:87], v[86:87]
  v_pk_fma_f32 v[24:25], v[24:25], v[18:19], v[16:17]
  v_pk_fma_f32 v[26:27], v[26:27], v[18:19], v[16:17]
  v_pk_fma_f32 v[28:29], v[28:29], v[18:19], v[16:17]
  v_pk_fma_f32 v[30:31], v[30:31], v[18:19], v[16:17]
  v_pk_mul_f32 v[24:25], v[24:25], v[80:81]
  v_pk_mul_f32 v[26:27], v[26:27], v[82:83]
  v_pk_mul_f32 v[28:29], v[28:29], v[84:85]
  v_pk_mul_f32 v[30:31], v[30:31], v[86:87]
  v_exp_f32 v24, v24
  v_exp_f32 v25, v25
  v_exp_f32 v26, v26
  v_exp_f32 v27, v27
  v_exp_f32 v28, v28
  v_exp_f32 v29, v29
  v_exp_f32 v30, v30
  v_exp_f32 v31, v31
  v_pk_add_f32 v[24:25], v[24:25], v[20:21]
  v_pk_add_f32 v[26:27], v[26:27], v[20:21]
  v_pk_add_f32 v[28:29], v[28:29], v[20:21]
  v_pk_add_f32 v[30:31], v[30:31], v[20:21]
  v_rcp_f32 v24, v24
  v_rcp_f32 v25, v25
  v_rcp_f32 v26, v26
  v_rcp_f32 v27, v27
  v_rcp_f32 v28, v28
  v_rcp_f32 v29, v29
  v_rcp_f32 v30, v30
  v_rcp_f32 v31, v31
  v_pk_mul_f32 v[24:25], v[24:25], v[80:81]
  v_pk_mul_f32 v[26:27], v[26:27], v[82:83]
  v_pk_mul_f32 v[28:29], v[28:29], v[84:85]
  v_pk_mul_f32 v[30:31], v[30:31], v[86:87]
  v_cvt_pk_bf16_f32 v48, v24, v25
  v_cvt_pk_bf16_f32 v49, v26, v27
  v_cvt_pk_bf16_f32 v50, v28, v29
  v_cvt_pk_bf16_f32 v51, v30, v31
  buffer_store_dwordx4 v[48:51], v4, s[56:59], s12 offen sc1
  s_add_u32 s12, s12, 4096
  v_pk_mul_f32 v[24:25], v[88:89], v[88:89]
  v_pk_mul_f32 v[26:27], v[90:91], v[90:91]
  v_pk_mul_f32 v[28:29], v[92:93], v[92:93]
  v_pk_mul_f32 v[30:31], v[94:95], v[94:95]
  v_pk_fma_f32 v[24:25], v[24:25], v[18:19], v[16:17]
  v_pk_fma_f32 v[26:27], v[26:27], v[18:19], v[16:17]
  v_pk_fma_f32 v[28:29], v[28:29], v[18:19], v[16:17]
  v_pk_fma_f32 v[30:31], v[30:31], v[18:19], v[16:17]
  v_pk_mul_f32 v[24:25], v[24:25], v[88:89]
  v_pk_mul_f32 v[26:27], v[26:27], v[90:91]
  v_pk_mul_f32 v[28:29], v[28:29], v[92:93]
  v_pk_mul_f32 v[30:31], v[30:31], v[94:95]
  v_exp_f32 v24, v24
  v_exp_f32 v25, v25
  v_exp_f32 v26, v26
  v_exp_f32 v27, v27
  v_exp_f32 v28, v28
  v_exp_f32 v29, v29
  v_exp_f32 v30, v30
  v_exp_f32 v31, v31
  v_pk_add_f32 v[24:25], v[24:25], v[20:21]
  v_pk_add_f32 v[26:27], v[26:27], v[20:21]
  v_pk_add_f32 v[28:29], v[28:29], v[20:21]
  v_pk_add_f32 v[30:31], v[30:31], v[20:21]
  v_rcp_f32 v24, v24
  v_rcp_f32 v25, v25
  v_rcp_f32 v26, v26
  v_rcp_f32 v27, v27
  v_rcp_f32 v28, v28
  v_rcp_f32 v29, v29
  v_rcp_f32 v30, v30
  v_rcp_f32 v31, v31
  v_pk_mul_f32 v[24:25], v[24:25], v[88:89]
  v_pk_mul_f32 v[26:27], v[26:27], v[90:91]
  v_pk_mul_f32 v[28:29], v[28:29], v[92:93]
  v_pk_mul_f32 v[30:31], v[30:31], v[94:95]
  v_cvt_pk_bf16_f32 v52, v24, v25
  v_cvt_pk_bf16_f32 v53, v26, v27
  v_cvt_pk_bf16_f32 v54, v28, v29
  v_cvt_pk_bf16_f32 v55, v30, v31
  buffer_store_dwordx4 v[52:55], v4, s[56:59], s12 offen sc1
  s_waitcnt vmcnt(0) lgkmcnt(0)
  v_mov_b32 v6, 157188
  v_mov_b32 v8, 1
  s_mov_b64 exec, 1
  ds_add_rtn_u32 v8, v6, v8
  s_waitcnt lgkmcnt(0)
  v_readfirstlane_b32 s10, v8
  s_mov_b64 exec, -1
  s_cmp_lg_u32 s10, 7
  s_cbranch_scc1 L_hp_6
  v_mov_b32 v6, 0
  s_mov_b64 exec, 1
  buffer_store_dword v5, v6, s[56:59], s93 offen sc1
  s_mov_b64 exec, -1
L_hp_6:
  s_mov_b32 s92, 0x100000
L_lw_7:
  ds_read_b32 v8, v7 offset:4
  s_waitcnt lgkmcnt(0)
  v_cmp_ne_u32 vcc, 8, v8
  s_nop 0
  s_cbranch_vccz L_lwd_8
  s_sleep 1
  s_sub_u32 s92, s92, 1
  s_cmp_lg_u32 s92, 0
  s_cbranch_scc1 L_lw_7
L_lwd_8:
  v_cmp_ne_u32 vcc, v11, v5
  s_nop 0
  s_cbranch_vccz L_fwok
L_fwpoll:
  s_mov_b32 s92, 0x40000
L_poll_9:
  buffer_load_dword v11, v10, s[56:59], s15 offen sc1
  s_waitcnt vmcnt(0)
  v_cmp_ne_u32 vcc, v11, v5
  s_nop 0
  s_cbranch_vccz L_pdone_10
  s_sleep 4
  s_sub_u32 s92, s92, 1
  s_cmp_lg_u32 s92, 0
  s_cbranch_scc1 L_poll_9
L_pdone_10:
L_fwok:
  s_mul_i32 s90, s8, 48
  s_add_u32 s90, s90, s77
  s_lshl_b32 s90, s90, 12
  s_add_u32 s90, s90, 0x900000
  s_mul_i32 s91, s9, 48
  s_add_u32 s91, s91, s77
  s_mul_i32 s91, s91, 5120
  s_add_u32 s91, s91, 0x400000
  v_add_u32 v9, 4096, v4
  s_add_u32 s11, s91, 0
  buffer_load_dwordx4 v[144:147], v4, s[56:59], s11 offen offset:0 sc1
  buffer_load_dwordx4 v[148:151], v4, s[56:59], s11 offen offset:1024 sc1
  buffer_load_dwordx4 v[152:155], v4, s[56:59], s11 offen offset:2048 sc1
  buffer_load_dwordx4 v[156:159], v4, s[56:59], s11 offen offset:3072 sc1
  buffer_load_dwordx4 v[160:163], v9, s[56:59], s11 offen sc1
  s_add_u32 s11, s91, 20480
  buffer_load_dwordx4 v[164:167], v4, s[56:59], s11 offen offset:0 sc1
  buffer_load_dwordx4 v[168:171], v4, s[56:59], s11 offen offset:1024 sc1
  buffer_load_dwordx4 v[172:175], v4, s[56:59], s11 offen offset:2048 sc1
  buffer_load_dwordx4 v[176:179], v4, s[56:59], s11 offen offset:3072 sc1
  buffer_load_dwordx4 v[180:183], v9, s[56:59], s11 offen sc1
  s_add_u32 s11, s91, 40960
  buffer_load_dwordx4 v[184:187], v4, s[56:59], s11 offen offset:0 sc1
  buffer_load_dwordx4 v[188:191], v4, s[56:59], s11 offen offset:1024 sc1
  buffer_load_dwordx4 v[192:195], v4, s[56:59], s11 offen offset:2048 sc1
  buffer_load_dwordx4 v[196:199], v4, s[56:59], s11 offen offset:3072 sc1
  buffer_load_dwordx4 v[200:203], v9, s[56:59], s11 offen sc1
  s_add_u32 s11, s91, 61440
  buffer_load_dwordx4 v[204:207], v4, s[56:59], s11 offen offset:0 sc1
  buffer_load_dwordx4 v[208:211], v4, s[56:59], s11 offen offset:1024 sc1
  buffer_load_dwordx4 v[212:215], v4, s[56:59], s11 offen offset:2048 sc1
  buffer_load_dwordx4 v[216:219], v4, s[56:59], s11 offen offset:3072 sc1
  buffer_load_dwordx4 v[220:223], v9, s[56:59], s11 offen sc1
L_gemm2:
  v_mov_b32 v16, 0
  v_mov_b32 v17, 0
  v_mov_b32 v18, 0
  v_mov_b32 v19, 0
  v_mov_b32 v20, 0
  v_mov_b32 v21, 0
  v_mov_b32 v22, 0
  v_mov_b32 v23, 0
  v_mov_b32 v24, 0
  v_mov_b32 v25, 0
  v_mov_b32 v26, 0
  v_mov_b32 v27, 0
  v_mov_b32 v28, 0
  v_mov_b32 v29, 0
  v_mov_b32 v30, 0
  v_mov_b32 v31, 0
  v_mov_b32 v32, 0
  v_mov_b32 v33, 0
  v_mov_b32 v34, 0
  v_mov_b32 v35, 0
  v_mov_b32 v36, 0
  v_mov_b32 v37, 0
  v_mov_b32 v38, 0
  v_mov_b32 v39, 0
  v_mov_b32 v40, 0
  v_mov_b32 v41, 0
  v_mov_b32 v42, 0
  v_mov_b32 v43, 0
  v_mov_b32 v44, 0
  v_mov_b32 v45, 0
  v_mov_b32 v46, 0
  v_mov_b32 v47, 0
  v_mov_b32 v48, 0
  v_mov_b32 v49, 0
  v_mov_b32 v50, 0
  v_mov_b32 v51, 0
  v_mov_b32 v52, 0
  v_mov_b32 v53, 0
  v_mov_b32 v54, 0
  v_mov_b32 v55, 0
  v_mov_b32 v56, 0
  v_mov_b32 v57, 0
  v_mov_b32 v58, 0
  v_mov_b32 v59, 0
  v_mov_b32 v60, 0
  v_mov_b32 v61, 0
  v_mov_b32 v62, 0
  v_mov_b32 v63, 0
  v_mov_b32 v64, 0
  v_mov_b32 v65, 0
  v_mov_b32 v66, 0
  v_mov_b32 v67, 0
  v_mov_b32 v68, 0
  v_mov_b32 v69, 0
  v_mov_b32 v70, 0
  v_mov_b32 v71, 0
  v_mov_b32 v72, 0
  v_mov_b32 v73, 0
  v_mov_b32 v74, 0
  v_mov_b32 v75, 0
  v_mov_b32 v76, 0
  v_mov_b32 v77, 0
  v_mov_b32 v78, 0
  v_mov_b32 v79, 0
  v_mov_b32 v80, 0
  v_mov_b32 v81, 0
  v_mov_b32 v82, 0
  v_mov_b32 v83, 0
  v_mov_b32 v84, 0
  v_mov_b32 v85, 0
  v_mov_b32 v86, 0
  v_mov_b32 v87, 0
  v_mov_b32 v88, 0
  v_mov_b32 v89, 0
  v_mov_b32 v90, 0
  v_mov_b32 v91, 0
  v_mov_b32 v92, 0
  v_mov_b32 v93, 0
  v_mov_b32 v94, 0
  v_mov_b32 v95, 0
  v_mov_b32 v7, 157184
  s_cmp_lg_u32 s77, 0
  s_cbranch_scc1 L_fhwait
  v_min_u32 v6, 11, v1
  v_lshlrev_b32 v6, 7, v6
  s_lshr_b32 s10, s8, 1
  s_lshl_b32 s10, s10, 11
  s_add_u32 s10, s10, 0x40000
  s_mov_b32 s92, 0x40000
L_poll_11:
  buffer_load_dword v8, v6, s[56:59], s10 offen sc1
  s_waitcnt vmcnt(0)
  v_cmp_ne_u32 vcc, v8, v5
  s_nop 0
  s_cbranch_vccz L_pdone_12
  s_sleep 16
  s_sub_u32 s92, s92, 1
  s_cmp_lg_u32 s92, 0
  s_cbranch_scc1 L_poll_11
L_pdone_12:
  ds_write_b32 v7, v5 offset:12
L_fhwait:
  s_mov_b32 s92, 0x100000
L_lw_13:
  ds_read_b32 v8, v7 offset:12
  s_waitcnt lgkmcnt(0)
  v_cmp_ne_u32 vcc, v5, v8
  s_nop 0
  s_cbranch_vccz L_lwd_14
  s_sleep 1
  s_sub_u32 s92, s92, 1
  s_cmp_lg_u32 s92, 0
  s_cbranch_scc1 L_lw_13
L_lwd_14:
  s_add_u32 s12, s90, 0
  buffer_load_dwordx4 v[224:227], v4, s[56:59], s12 offen offset:0 sc1
  buffer_load_dwordx4 v[228:231], v4, s[56:59], s12 offen offset:1024 sc1
  buffer_load_dwordx4 v[232:235], v4, s[56:59], s12 offen offset:2048 sc1
  buffer_load_dwordx4 v[236:239], v4, s[56:59], s12 offen offset:3072 sc1
  s_add_u32 s12, s90, 16384
  buffer_load_dwordx4 v[240:243], v4, s[56:59], s12 offen offset:0 sc1
  buffer_load_dwordx4 v[244:247], v4, s[56:59], s12 offen offset:1024 sc1
  buffer_load_dwordx4 v[248:251], v4, s[56:59], s12 offen offset:2048 sc1
  buffer_load_dwordx4 v[96:99], v4, s[56:59], s12 offen offset:3072 sc1
  s_add_u32 s12, s90, 32768
  buffer_load_dwordx4 v[100:103], v4, s[56:59], s12 offen offset:0 sc1
  buffer_load_dwordx4 v[104:107], v4, s[56:59], s12 offen offset:1024 sc1
  buffer_load_dwordx4 v[108:111], v4, s[56:59], s12 offen offset:2048 sc1
  buffer_load_dwordx4 v[112:115], v4, s[56:59], s12 offen offset:3072 sc1
  s_add_u32 s12, s90, 49152
  buffer_load_dwordx4 v[116:119], v4, s[56:59], s12 offen offset:0 sc1
  buffer_load_dwordx4 v[120:123], v4, s[56:59], s12 offen offset:1024 sc1
  buffer_load_dwordx4 v[124:127], v4, s[56:59], s12 offen offset:2048 sc1
  buffer_load_dwordx4 v[128:131], v4, s[56:59], s12 offen offset:3072 sc1
  s_waitcnt vmcnt(12)
  v_mfma_f32_16x16x32_bf16 v[16:19], v[144:147], v[224:227], v[16:19]
  v_mfma_f32_16x16x32_bf16 v[36:39], v[144:147], v[228:231], v[36:39]
  v_mfma_f32_16x16x32_bf16 v[56:59], v[144:147], v[232:235], v[56:59]
  v_mfma_f32_16x16x32_bf16 v[76:79], v[144:147], v[236:239], v[76:79]
  v_mfma_f32_16x16x32_bf16 v[20:23], v[148:151], v[224:227], v[20:23]
  v_mfma_f32_16x16x32_bf16 v[40:43], v[148:151], v[228:231], v[40:43]
  v_mfma_f32_16x16x32_bf16 v[60:63], v[148:151], v[232:235], v[60:63]
  v_mfma_f32_16x16x32_bf16 v[80:83], v[148:151], v[236:239], v[80:83]
  v_mfma_f32_16x16x32_bf16 v[24:27], v[152:155], v[224:227], v[24:27]
  v_mfma_f32_16x16x32_bf16 v[44:47], v[152:155], v[228:231], v[44:47]
  v_mfma_f32_16x16x32_bf16 v[64:67], v[152:155], v[232:235], v[64:67]
  v_mfma_f32_16x16x32_bf16 v[84:87], v[152:155], v[236:239], v[84:87]
  v_mfma_f32_16x16x32_bf16 v[28:31], v[156:159], v[224:227], v[28:31]
  v_mfma_f32_16x16x32_bf16 v[48:51], v[156:159], v[228:231], v[48:51]
  v_mfma_f32_16x16x32_bf16 v[68:71], v[156:159], v[232:235], v[68:71]
  v_mfma_f32_16x16x32_bf16 v[88:91], v[156:159], v[236:239], v[88:91]
  v_mfma_f32_16x16x32_bf16 v[32:35], v[160:163], v[224:227], v[32:35]
  v_mfma_f32_16x16x32_bf16 v[52:55], v[160:163], v[228:231], v[52:55]
  v_mfma_f32_16x16x32_bf16 v[72:75], v[160:163], v[232:235], v[72:75]
  v_mfma_f32_16x16x32_bf16 v[92:95], v[160:163], v[236:239], v[92:95]
  s_add_u32 s12, s90, 65536
  buffer_load_dwordx4 v[132:135], v4, s[56:59], s12 offen offset:0 sc1
  buffer_load_dwordx4 v[136:139], v4, s[56:59], s12 offen offset:1024 sc1
  buffer_load_dwordx4 v[140:143], v4, s[56:59], s12 offen offset:2048 sc1
  buffer_load_dwordx4 v[144:147], v4, s[56:59], s12 offen offset:3072 sc1
  s_add_u32 s11, s91, 81920
  buffer_load_dwordx4 v[148:151], v4, s[56:59], s11 offen offset:0 sc1
  buffer_load_dwordx4 v[152:155], v4, s[56:59], s11 offen offset:1024 sc1
  buffer_load_dwordx4 v[156:159], v4, s[56:59], s11 offen offset:2048 sc1
  buffer_load_dwordx4 v[160:163], v4, s[56:59], s11 offen offset:3072 sc1
  buffer_load_dwordx4 v[224:227], v9, s[56:59], s11 offen sc1
  s_waitcnt vmcnt(17)
  v_mfma_f32_16x16x32_bf16 v[16:19], v[164:167], v[240:243], v[16:19]
  v_mfma_f32_16x16x32_bf16 v[36:39], v[164:167], v[244:247], v[36:39]
  v_mfma_f32_16x16x32_bf16 v[56:59], v[164:167], v[248:251], v[56:59]
  v_mfma_f32_16x16x32_bf16 v[76:79], v[164:167], v[96:99], v[76:79]
  v_mfma_f32_16x16x32_bf16 v[20:23], v[168:171], v[240:243], v[20:23]
  v_mfma_f32_16x16x32_bf16 v[40:43], v[168:171], v[244:247], v[40:43]
  v_mfma_f32_16x16x32_bf16 v[60:63], v[168:171], v[248:251], v[60:63]
  v_mfma_f32_16x16x32_bf16 v[80:83], v[168:171], v[96:99], v[80:83]
  v_mfma_f32_16x16x32_bf16 v[24:27], v[172:175], v[240:243], v[24:27]
  v_mfma_f32_16x16x32_bf16 v[44:47], v[172:175], v[244:247], v[44:47]
  v_mfma_f32_16x16x32_bf16 v[64:67], v[172:175], v[248:251], v[64:67]
  v_mfma_f32_16x16x32_bf16 v[84:87], v[172:175], v[96:99], v[84:87]
  v_mfma_f32_16x16x32_bf16 v[28:31], v[176:179], v[240:243], v[28:31]
  v_mfma_f32_16x16x32_bf16 v[48:51], v[176:179], v[244:247], v[48:51]
  v_mfma_f32_16x16x32_bf16 v[68:71], v[176:179], v[248:251], v[68:71]
  v_mfma_f32_16x16x32_bf16 v[88:91], v[176:179], v[96:99], v[88:91]
  v_mfma_f32_16x16x32_bf16 v[32:35], v[180:183], v[240:243], v[32:35]
  v_mfma_f32_16x16x32_bf16 v[52:55], v[180:183], v[244:247], v[52:55]
  v_mfma_f32_16x16x32_bf16 v[72:75], v[180:183], v[248:251], v[72:75]
  v_mfma_f32_16x16x32_bf16 v[92:95], v[180:183], v[96:99], v[92:95]
  s_add_u32 s12, s90, 81920
  buffer_load_dwordx4 v[228:231], v4, s[56:59], s12 offen offset:0 sc1
  buffer_load_dwordx4 v[232:235], v4, s[56:59], s12 offen offset:1024 sc1
  buffer_load_dwordx4 v[236:239], v4, s[56:59], s12 offen offset:2048 sc1
  buffer_load_dwordx4 v[164:167], v4, s[56:59], s12 offen offset:3072 sc1
  s_add_u32 s11, s91, 102400
  buffer_load_dwordx4 v[168:171], v4, s[56:59], s11 offen offset:0 sc1
  buffer_load_dwordx4 v[172:175], v4, s[56:59], s11 offen offset:1024 sc1
  buffer_load_dwordx4 v[176:179], v4, s[56:59], s11 offen offset:2048 sc1
  buffer_load_dwordx4 v[180:183], v4, s[56:59], s11 offen offset:3072 sc1
  buffer_load_dwordx4 v[240:243], v9, s[56:59], s11 offen sc1
  s_waitcnt vmcnt(22)
  v_mfma_f32_16x16x32_bf16 v[16:19], v[184:187], v[100:103], v[16:19]
  v_mfma_f32_16x16x32_bf16 v[36:39], v[184:187], v[104:107], v[36:39]
  v_mfma_f32_16x16x32_bf16 v[56:59], v[184:187], v[108:111], v[56:59]
  v_mfma_f32_16x16x32_bf16 v[76:79], v[184:187], v[112:115], v[76:79]
  v_mfma_f32_16x16x32_bf16 v[20:23], v[188:191], v[100:103], v[20:23]
  v_mfma_f32_16x16x32_bf16 v[40:43], v[188:191], v[104:107], v[40:43]
  v_mfma_f32_16x16x32_bf16 v[60:63], v[188:191], v[108:111], v[60:63]
  v_mfma_f32_16x16x32_bf16 v[80:83], v[188:191], v[112:115], v[80:83]
  v_mfma_f32_16x16x32_bf16 v[24:27], v[192:195], v[100:103], v[24:27]
  v_mfma_f32_16x16x32_bf16 v[44:47], v[192:195], v[104:107], v[44:47]
  v_mfma_f32_16x16x32_bf16 v[64:67], v[192:195], v[108:111], v[64:67]
  v_mfma_f32_16x16x32_bf16 v[84:87], v[192:195], v[112:115], v[84:87]
  v_mfma_f32_16x16x32_bf16 v[28:31], v[196:199], v[100:103], v[28:31]
  v_mfma_f32_16x16x32_bf16 v[48:51], v[196:199], v[104:107], v[48:51]
  v_mfma_f32_16x16x32_bf16 v[68:71], v[196:199], v[108:111], v[68:71]
  v_mfma_f32_16x16x32_bf16 v[88:91], v[196:199], v[112:115], v[88:91]
  v_mfma_f32_16x16x32_bf16 v[32:35], v[200:203], v[100:103], v[32:35]
  v_mfma_f32_16x16x32_bf16 v[52:55], v[200:203], v[104:107], v[52:55]
  v_mfma_f32_16x16x32_bf16 v[72:75], v[200:203], v[108:111], v[72:75]
  v_mfma_f32_16x16x32_bf16 v[92:95], v[200:203], v[112:115], v[92:95]
  s_add_u32 s12, s90, 98304
  buffer_load_dwordx4 v[244:247], v4, s[56:59], s12 offen offset:0 sc1
  buffer_load_dwordx4 v[248:251], v4, s[56:59], s12 offen offset:1024 sc1
  buffer_load_dwordx4 v[96:99], v4, s[56:59], s12 offen offset:2048 sc1
  buffer_load_dwordx4 v[184:187], v4, s[56:59], s12 offen offset:3072 sc1
  s_add_u32 s11, s91, 122880
  buffer_load_dwordx4 v[188:191], v4, s[56:59], s11 offen offset:0 sc1
  buffer_load_dwordx4 v[192:195], v4, s[56:59], s11 offen offset:1024 sc1
  buffer_load_dwordx4 v[196:199], v4, s[56:59], s11 offen offset:2048 sc1
  buffer_load_dwordx4 v[200:203], v4, s[56:59], s11 offen offset:3072 sc1
  buffer_load_dwordx4 v[100:103], v9, s[56:59], s11 offen sc1
  s_waitcnt vmcnt(27)
  v_mfma_f32_16x16x32_bf16 v[16:19], v[204:207], v[116:119], v[16:19]
  v_mfma_f32_16x16x32_bf16 v[36:39], v[204:207], v[120:123], v[36:39]
  v_mfma_f32_16x16x32_bf16 v[56:59], v[204:207], v[124:127], v[56:59]
  v_mfma_f32_16x16x32_bf16 v[76:79], v[204:207], v[128:131], v[76:79]
  v_mfma_f32_16x16x32_bf16 v[20:23], v[208:211], v[116:119], v[20:23]
  v_mfma_f32_16x16x32_bf16 v[40:43], v[208:211], v[120:123], v[40:43]
  v_mfma_f32_16x16x32_bf16 v[60:63], v[208:211], v[124:127], v[60:63]
  v_mfma_f32_16x16x32_bf16 v[80:83], v[208:211], v[128:131], v[80:83]
  v_mfma_f32_16x16x32_bf16 v[24:27], v[212:215], v[116:119], v[24:27]
  v_mfma_f32_16x16x32_bf16 v[44:47], v[212:215], v[120:123], v[44:47]
  v_mfma_f32_16x16x32_bf16 v[64:67], v[212:215], v[124:127], v[64:67]
  v_mfma_f32_16x16x32_bf16 v[84:87], v[212:215], v[128:131], v[84:87]
  v_mfma_f32_16x16x32_bf16 v[28:31], v[216:219], v[116:119], v[28:31]
  v_mfma_f32_16x16x32_bf16 v[48:51], v[216:219], v[120:123], v[48:51]
  v_mfma_f32_16x16x32_bf16 v[68:71], v[216:219], v[124:127], v[68:71]
  v_mfma_f32_16x16x32_bf16 v[88:91], v[216:219], v[128:131], v[88:91]
  v_mfma_f32_16x16x32_bf16 v[32:35], v[220:223], v[116:119], v[32:35]
  v_mfma_f32_16x16x32_bf16 v[52:55], v[220:223], v[120:123], v[52:55]
  v_mfma_f32_16x16x32_bf16 v[72:75], v[220:223], v[124:127], v[72:75]
  v_mfma_f32_16x16x32_bf16 v[92:95], v[220:223], v[128:131], v[92:95]
  s_add_u32 s12, s90, 114688
  buffer_load_dwordx4 v[104:107], v4, s[56:59], s12 offen offset:0 sc1
  buffer_load_dwordx4 v[108:111], v4, s[56:59], s12 offen offset:1024 sc1
  buffer_load_dwordx4 v[112:115], v4, s[56:59], s12 offen offset:2048 sc1
  buffer_load_dwordx4 v[204:207], v4, s[56:59], s12 offen offset:3072 sc1
  s_add_u32 s11, s91, 143360
  buffer_load_dwordx4 v[208:211], v4, s[56:59], s11 offen offset:0 sc1
  buffer_load_dwordx4 v[212:215], v4, s[56:59], s11 offen offset:1024 sc1
  buffer_load_dwordx4 v[216:219], v4, s[56:59], s11 offen offset:2048 sc1
  buffer_load_dwordx4 v[220:223], v4, s[56:59], s11 offen offset:3072 sc1
  buffer_load_dwordx4 v[116:119], v9, s[56:59], s11 offen sc1
  s_waitcnt vmcnt(32)
  s_waitcnt vmcnt(27)
  v_mfma_f32_16x16x32_bf16 v[16:19], v[148:151], v[132:135], v[16:19]
  v_mfma_f32_16x16x32_bf16 v[36:39], v[148:151], v[136:139], v[36:39]
  v_mfma_f32_16x16x32_bf16 v[56:59], v[148:151], v[140:143], v[56:59]
  v_mfma_f32_16x16x32_bf16 v[76:79], v[148:151], v[144:147], v[76:79]
  v_mfma_f32_16x16x32_bf16 v[20:23], v[152:155], v[132:135], v[20:23]
  v_mfma_f32_16x16x32_bf16 v[40:43], v[152:155], v[136:139], v[40:43]
  v_mfma_f32_16x16x32_bf16 v[60:63], v[152:155], v[140:143], v[60:63]
  v_mfma_f32_16x16x32_bf16 v[80:83], v[152:155], v[144:147], v[80:83]
  v_mfma_f32_16x16x32_bf16 v[24:27], v[156:159], v[132:135], v[24:27]
  v_mfma_f32_16x16x32_bf16 v[44:47], v[156:159], v[136:139], v[44:47]
  v_mfma_f32_16x16x32_bf16 v[64:67], v[156:159], v[140:143], v[64:67]
  v_mfma_f32_16x16x32_bf16 v[84:87], v[156:159], v[144:147], v[84:87]
  v_mfma_f32_16x16x32_bf16 v[28:31], v[160:163], v[132:135], v[28:31]
  v_mfma_f32_16x16x32_bf16 v[48:51], v[160:163], v[136:139], v[48:51]
  v_mfma_f32_16x16x32_bf16 v[68:71], v[160:163], v[140:143], v[68:71]
  v_mfma_f32_16x16x32_bf16 v[88:91], v[160:163], v[144:147], v[88:91]
  v_mfma_f32_16x16x32_bf16 v[32:35], v[224:227], v[132:135], v[32:35]
  v_mfma_f32_16x16x32_bf16 v[52:55], v[224:227], v[136:139], v[52:55]
  v_mfma_f32_16x16x32_bf16 v[72:75], v[224:227], v[140:143], v[72:75]
  v_mfma_f32_16x16x32_bf16 v[92:95], v[224:227], v[144:147], v[92:95]
  s_add_u32 s12, s90, 131072
  buffer_load_dwordx4 v[120:123], v4, s[56:59], s12 offen offset:0 sc1
  buffer_load_dwordx4 v[124:127], v4, s[56:59], s12 offen offset:1024 sc1
  buffer_load_dwordx4 v[128:131], v4, s[56:59], s12 offen offset:2048 sc1
  buffer_load_dwordx4 v[148:151], v4, s[56:59], s12 offen offset:3072 sc1
  s_add_u32 s11, s91, 163840
  buffer_load_dwordx4 v[152:155], v4, s[56:59], s11 offen offset:0 sc1
  buffer_load_dwordx4 v[156:159], v4, s[56:59], s11 offen offset:1024 sc1
  buffer_load_dwordx4 v[160:163], v4, s[56:59], s11 offen offset:2048 sc1
  buffer_load_dwordx4 v[224:227], v4, s[56:59], s11 offen offset:3072 sc1
  buffer_load_dwordx4 v[132:135], v9, s[56:59], s11 offen sc1
  s_waitcnt vmcnt(32)
  s_waitcnt vmcnt(27)
  v_mfma_f32_16x16x32_bf16 v[16:19], v[168:171], v[228:231], v[16:19]
  v_mfma_f32_16x16x32_bf16 v[36:39], v[168:171], v[232:235], v[36:39]
  v_mfma_f32_16x16x32_bf16 v[56:59], v[168:171], v[236:239], v[56:59]
  v_mfma_f32_16x16x32_bf16 v[76:79], v[168:171], v[164:167], v[76:79]
  v_mfma_f32_16x16x32_bf16 v[20:23], v[172:175], v[228:231], v[20:23]
  v_mfma_f32_16x16x32_bf16 v[40:43], v[172:175], v[232:235], v[40:43]
  v_mfma_f32_16x16x32_bf16 v[60:63], v[172:175], v[236:239], v[60:63]
  v_mfma_f32_16x16x32_bf16 v[80:83], v[172:175], v[164:167], v[80:83]
  v_mfma_f32_16x16x32_bf16 v[24:27], v[176:179], v[228:231], v[24:27]
  v_mfma_f32_16x16x32_bf16 v[44:47], v[176:179], v[232:235], v[44:47]
  v_mfma_f32_16x16x32_bf16 v[64:67], v[176:179], v[236:239], v[64:67]
  v_mfma_f32_16x16x32_bf16 v[84:87], v[176:179], v[164:167], v[84:87]
  v_mfma_f32_16x16x32_bf16 v[28:31], v[180:183], v[228:231], v[28:31]
  v_mfma_f32_16x16x32_bf16 v[48:51], v[180:183], v[232:235], v[48:51]
  v_mfma_f32_16x16x32_bf16 v[68:71], v[180:183], v[236:239], v[68:71]
  v_mfma_f32_16x16x32_bf16 v[88:91], v[180:183], v[164:167], v[88:91]
  v_mfma_f32_16x16x32_bf16 v[32:35], v[240:243], v[228:231], v[32:35]
  v_mfma_f32_16x16x32_bf16 v[52:55], v[240:243], v[232:235], v[52:55]
  v_mfma_f32_16x16x32_bf16 v[72:75], v[240:243], v[236:239], v[72:75]
  v_mfma_f32_16x16x32_bf16 v[92:95], v[240:243], v[164:167], v[92:95]
  s_add_u32 s12, s90, 147456
  buffer_load_dwordx4 v[136:139], v4, s[56:59], s12 offen offset:0 sc1
  buffer_load_dwordx4 v[140:143], v4, s[56:59], s12 offen offset:1024 sc1
  buffer_load_dwordx4 v[144:147], v4, s[56:59], s12 offen offset:2048 sc1
  buffer_load_dwordx4 v[168:171], v4, s[56:59], s12 offen offset:3072 sc1
  s_add_u32 s11, s91, 184320
  buffer_load_dwordx4 v[172:175], v4, s[56:59], s11 offen offset:0 sc1
  buffer_load_dwordx4 v[176:179], v4, s[56:59], s11 offen offset:1024 sc1
  buffer_load_dwordx4 v[180:183], v4, s[56:59], s11 offen offset:2048 sc1
  buffer_load_dwordx4 v[240:243], v4, s[56:59], s11 offen offset:3072 sc1
  buffer_load_dwordx4 v[228:231], v9, s[56:59], s11 offen sc1
  s_waitcnt vmcnt(32)
  s_waitcnt vmcnt(27)
  v_mfma_f32_16x16x32_bf16 v[16:19], v[188:191], v[244:247], v[16:19]
  v_mfma_f32_16x16x32_bf16 v[36:39], v[188:191], v[248:251], v[36:39]
  v_mfma_f32_16x16x32_bf16 v[56:59], v[188:191], v[96:99], v[56:59]
  v_mfma_f32_16x16x32_bf16 v[76:79], v[188:191], v[184:187], v[76:79]
  v_mfma_f32_16x16x32_bf16 v[20:23], v[192:195], v[244:247], v[20:23]
  v_mfma_f32_16x16x32_bf16 v[40:43], v[192:195], v[248:251], v[40:43]
  v_mfma_f32_16x16x32_bf16 v[60:63], v[192:195], v[96:99], v[60:63]
  v_mfma_f32_16x16x32_bf16 v[80:83], v[192:195], v[184:187], v[80:83]
  v_mfma_f32_16x16x32_bf16 v[24:27], v[196:199], v[244:247], v[24:27]
  v_mfma_f32_16x16x32_bf16 v[44:47], v[196:199], v[248:251], v[44:47]
  v_mfma_f32_16x16x32_bf16 v[64:67], v[196:199], v[96:99], v[64:67]
  v_mfma_f32_16x16x32_bf16 v[84:87], v[196:199], v[184:187], v[84:87]
  v_mfma_f32_16x16x32_bf16 v[28:31], v[200:203], v[244:247], v[28:31]
  v_mfma_f32_16x16x32_bf16 v[48:51], v[200:203], v[248:251], v[48:51]
  v_mfma_f32_16x16x32_bf16 v[68:71], v[200:203], v[96:99], v[68:71]
  v_mfma_f32_16x16x32_bf16 v[88:91], v[200:203], v[184:187], v[88:91]
  v_mfma_f32_16x16x32_bf16 v[32:35], v[100:103], v[244:247], v[32:35]
  v_mfma_f32_16x16x32_bf16 v[52:55], v[100:103], v[248:251], v[52:55]
  v_mfma_f32_16x16x32_bf16 v[72:75], v[100:103], v[96:99], v[72:75]
  v_mfma_f32_16x16x32_bf16 v[92:95], v[100:103], v[184:187], v[92:95]
  s_add_u32 s12, s90, 163840
  buffer_load_dwordx4 v[232:235], v4, s[56:59], s12 offen offset:0 sc1
  buffer_load_dwordx4 v[236:239], v4, s[56:59], s12 offen offset:1024 sc1
  buffer_load_dwordx4 v[164:167], v4, s[56:59], s12 offen offset:2048 sc1
  buffer_load_dwordx4 v[188:191], v4, s[56:59], s12 offen offset:3072 sc1
  s_add_u32 s11, s91, 204800
  buffer_load_dwordx4 v[192:195], v4, s[56:59], s11 offen offset:0 sc1
  buffer_load_dwordx4 v[196:199], v4, s[56:59], s11 offen offset:1024 sc1
  buffer_load_dwordx4 v[200:203], v4, s[56:59], s11 offen offset:2048 sc1
  buffer_load_dwordx4 v[100:103], v4, s[56:59], s11 offen offset:3072 sc1
  buffer_load_dwordx4 v[244:247], v9, s[56:59], s11 offen sc1
  ds_write_b32 v7, v5 offset:40
  s_waitcnt vmcnt(32)
  s_waitcnt vmcnt(27)
  v_mfma_f32_16x16x32_bf16 v[16:19], v[208:211], v[104:107], v[16:19]
  v_mfma_f32_16x16x32_bf16 v[36:39], v[208:211], v[108:111], v[36:39]
  v_mfma_f32_16x16x32_bf16 v[56:59], v[208:211], v[112:115], v[56:59]
  v_mfma_f32_16x16x32_bf16 v[76:79], v[208:211], v[204:207], v[76:79]
  v_mfma_f32_16x16x32_bf16 v[20:23], v[212:215], v[104:107], v[20:23]
  v_mfma_f32_16x16x32_bf16 v[40:43], v[212:215], v[108:111], v[40:43]
  v_mfma_f32_16x16x32_bf16 v[60:63], v[212:215], v[112:115], v[60:63]
  v_mfma_f32_16x16x32_bf16 v[80:83], v[212:215], v[204:207], v[80:83]
  v_mfma_f32_16x16x32_bf16 v[24:27], v[216:219], v[104:107], v[24:27]
  v_mfma_f32_16x16x32_bf16 v[44:47], v[216:219], v[108:111], v[44:47]
  v_mfma_f32_16x16x32_bf16 v[64:67], v[216:219], v[112:115], v[64:67]
  v_mfma_f32_16x16x32_bf16 v[84:87], v[216:219], v[204:207], v[84:87]
  v_mfma_f32_16x16x32_bf16 v[28:31], v[220:223], v[104:107], v[28:31]
  v_mfma_f32_16x16x32_bf16 v[48:51], v[220:223], v[108:111], v[48:51]
  v_mfma_f32_16x16x32_bf16 v[68:71], v[220:223], v[112:115], v[68:71]
  v_mfma_f32_16x16x32_bf16 v[88:91], v[220:223], v[204:207], v[88:91]
  v_mfma_f32_16x16x32_bf16 v[32:35], v[116:119], v[104:107], v[32:35]
  v_mfma_f32_16x16x32_bf16 v[52:55], v[116:119], v[108:111], v[52:55]
  v_mfma_f32_16x16x32_bf16 v[72:75], v[116:119], v[112:115], v[72:75]
  v_mfma_f32_16x16x32_bf16 v[92:95], v[116:119], v[204:207], v[92:95]
  s_add_u32 s12, s90, 180224
  buffer_load_dwordx4 v[248:251], v4, s[56:59], s12 offen offset:0 sc1
  buffer_load_dwordx4 v[96:99], v4, s[56:59], s12 offen offset:1024 sc1
  buffer_load_dwordx4 v[184:187], v4, s[56:59], s12 offen offset:2048 sc1
  buffer_load_dwordx4 v[208:211], v4, s[56:59], s12 offen offset:3072 sc1
  s_add_u32 s11, s91, 225280
  buffer_load_dwordx4 v[212:215], v4, s[56:59], s11 offen offset:0 sc1
  buffer_load_dwordx4 v[216:219], v4, s[56:59], s11 offen offset:1024 sc1
  buffer_load_dwordx4 v[220:223], v4, s[56:59], s11 offen offset:2048 sc1
  buffer_load_dwordx4 v[116:119], v4, s[56:59], s11 offen offset:3072 sc1
  buffer_load_dwordx4 v[104:107], v9, s[56:59], s11 offen sc1
  s_waitcnt vmcnt(32)
  s_waitcnt vmcnt(27)
  v_mfma_f32_16x16x32_bf16 v[16:19], v[152:155], v[120:123], v[16:19]
  v_mfma_f32_16x16x32_bf16 v[36:39], v[152:155], v[124:127], v[36:39]
  v_mfma_f32_16x16x32_bf16 v[56:59], v[152:155], v[128:131], v[56:59]
  v_mfma_f32_16x16x32_bf16 v[76:79], v[152:155], v[148:151], v[76:79]
  v_mfma_f32_16x16x32_bf16 v[20:23], v[156:159], v[120:123], v[20:23]
  v_mfma_f32_16x16x32_bf16 v[40:43], v[156:159], v[124:127], v[40:43]
  v_mfma_f32_16x16x32_bf16 v[60:63], v[156:159], v[128:131], v[60:63]
  v_mfma_f32_16x16x32_bf16 v[80:83], v[156:159], v[148:151], v[80:83]
  v_mfma_f32_16x16x32_bf16 v[24:27], v[160:163], v[120:123], v[24:27]
  v_mfma_f32_16x16x32_bf16 v[44:47], v[160:163], v[124:127], v[44:47]
  v_mfma_f32_16x16x32_bf16 v[64:67], v[160:163], v[128:131], v[64:67]
  v_mfma_f32_16x16x32_bf16 v[84:87], v[160:163], v[148:151], v[84:87]
  v_mfma_f32_16x16x32_bf16 v[28:31], v[224:227], v[120:123], v[28:31]
  v_mfma_f32_16x16x32_bf16 v[48:51], v[224:227], v[124:127], v[48:51]
  v_mfma_f32_16x16x32_bf16 v[68:71], v[224:227], v[128:131], v[68:71]
  v_mfma_f32_16x16x32_bf16 v[88:91], v[224:227], v[148:151], v[88:91]
  v_mfma_f32_16x16x32_bf16 v[32:35], v[132:135], v[120:123], v[32:35]
  v_mfma_f32_16x16x32_bf16 v[52:55], v[132:135], v[124:127], v[52:55]
  v_mfma_f32_16x16x32_bf16 v[72:75], v[132:135], v[128:131], v[72:75]
  v_mfma_f32_16x16x32_bf16 v[92:95], v[132:135], v[148:151], v[92:95]
  s_waitcnt vmcnt(23)
  s_waitcnt vmcnt(18)
  v_mfma_f32_16x16x32_bf16 v[16:19], v[172:175], v[136:139], v[16:19]
  v_mfma_f32_16x16x32_bf16 v[36:39], v[172:175], v[140:143], v[36:39]
  v_mfma_f32_16x16x32_bf16 v[56:59], v[172:175], v[144:147], v[56:59]
  v_mfma_f32_16x16x32_bf16 v[76:79], v[172:175], v[168:171], v[76:79]
  v_mfma_f32_16x16x32_bf16 v[20:23], v[176:179], v[136:139], v[20:23]
  v_mfma_f32_16x16x32_bf16 v[40:43], v[176:179], v[140:143], v[40:43]
  v_mfma_f32_16x16x32_bf16 v[60:63], v[176:179], v[144:147], v[60:63]
  v_mfma_f32_16x16x32_bf16 v[80:83], v[176:179], v[168:171], v[80:83]
  v_mfma_f32_16x16x32_bf16 v[24:27], v[180:183], v[136:139], v[24:27]
  v_mfma_f32_16x16x32_bf16 v[44:47], v[180:183], v[140:143], v[44:47]
  v_mfma_f32_16x16x32_bf16 v[64:67], v[180:183], v[144:147], v[64:67]
  v_mfma_f32_16x16x32_bf16 v[84:87], v[180:183], v[168:171], v[84:87]
  v_mfma_f32_16x16x32_bf16 v[28:31], v[240:243], v[136:139], v[28:31]
  v_mfma_f32_16x16x32_bf16 v[48:51], v[240:243], v[140:143], v[48:51]
  v_mfma_f32_16x16x32_bf16 v[68:71], v[240:243], v[144:147], v[68:71]
  v_mfma_f32_16x16x32_bf16 v[88:91], v[240:243], v[168:171], v[88:91]
  v_mfma_f32_16x16x32_bf16 v[32:35], v[228:231], v[136:139], v[32:35]
  v_mfma_f32_16x16x32_bf16 v[52:55], v[228:231], v[140:143], v[52:55]
  v_mfma_f32_16x16x32_bf16 v[72:75], v[228:231], v[144:147], v[72:75]
  v_mfma_f32_16x16x32_bf16 v[92:95], v[228:231], v[168:171], v[92:95]
  s_waitcnt vmcnt(14)
  s_waitcnt vmcnt(9)
  v_mfma_f32_16x16x32_bf16 v[16:19], v[192:195], v[232:235], v[16:19]
  v_mfma_f32_16x16x32_bf16 v[36:39], v[192:195], v[236:239], v[36:39]
  v_mfma_f32_16x16x32_bf16 v[56:59], v[192:195], v[164:167], v[56:59]
  v_mfma_f32_16x16x32_bf16 v[76:79], v[192:195], v[188:191], v[76:79]
  v_mfma_f32_16x16x32_bf16 v[20:23], v[196:199], v[232:235], v[20:23]
  v_mfma_f32_16x16x32_bf16 v[40:43], v[196:199], v[236:239], v[40:43]
  v_mfma_f32_16x16x32_bf16 v[60:63], v[196:199], v[164:167], v[60:63]
  v_mfma_f32_16x16x32_bf16 v[80:83], v[196:199], v[188:191], v[80:83]
  v_mfma_f32_16x16x32_bf16 v[24:27], v[200:203], v[232:235], v[24:27]
  v_mfma_f32_16x16x32_bf16 v[44:47], v[200:203], v[236:239], v[44:47]
  v_mfma_f32_16x16x32_bf16 v[64:67], v[200:203], v[164:167], v[64:67]
  v_mfma_f32_16x16x32_bf16 v[84:87], v[200:203], v[188:191], v[84:87]
  v_mfma_f32_16x16x32_bf16 v[28:31], v[100:103], v[232:235], v[28:31]
  v_mfma_f32_16x16x32_bf16 v[48:51], v[100:103], v[236:239], v[48:51]
  v_mfma_f32_16x16x32_bf16 v[68:71], v[100:103], v[164:167], v[68:71]
  v_mfma_f32_16x16x32_bf16 v[88:91], v[100:103], v[188:191], v[88:91]
  v_mfma_f32_16x16x32_bf16 v[32:35], v[244:247], v[232:235], v[32:35]
  v_mfma_f32_16x16x32_bf16 v[52:55], v[244:247], v[236:239], v[52:55]
  v_mfma_f32_16x16x32_bf16 v[72:75], v[244:247], v[164:167], v[72:75]
  v_mfma_f32_16x16x32_bf16 v[92:95], v[244:247], v[188:191], v[92:95]
  s_waitcnt vmcnt(5)
  s_waitcnt vmcnt(0)
  v_mfma_f32_16x16x32_bf16 v[16:19], v[212:215], v[248:251], v[16:19]
  v_mfma_f32_16x16x32_bf16 v[36:39], v[212:215], v[96:99], v[36:39]
  v_mfma_f32_16x16x32_bf16 v[56:59], v[212:215], v[184:187], v[56:59]
  v_mfma_f32_16x16x32_bf16 v[76:79], v[212:215], v[208:211], v[76:79]
  v_mfma_f32_16x16x32_bf16 v[20:23], v[216:219], v[248:251], v[20:23]
  v_mfma_f32_16x16x32_bf16 v[40:43], v[216:219], v[96:99], v[40:43]
  v_mfma_f32_16x16x32_bf16 v[60:63], v[216:219], v[184:187], v[60:63]
  v_mfma_f32_16x16x32_bf16 v[80:83], v[216:219], v[208:211], v[80:83]
  v_mfma_f32_16x16x32_bf16 v[24:27], v[220:223], v[248:251], v[24:27]
  v_mfma_f32_16x16x32_bf16 v[44:47], v[220:223], v[96:99], v[44:47]
  v_mfma_f32_16x16x32_bf16 v[64:67], v[220:223], v[184:187], v[64:67]
  v_mfma_f32_16x16x32_bf16 v[84:87], v[220:223], v[208:211], v[84:87]
  v_mfma_f32_16x16x32_bf16 v[28:31], v[116:119], v[248:251], v[28:31]
  v_mfma_f32_16x16x32_bf16 v[48:51], v[116:119], v[96:99], v[48:51]
  v_mfma_f32_16x16x32_bf16 v[68:71], v[116:119], v[184:187], v[68:71]
  v_mfma_f32_16x16x32_bf16 v[88:91], v[116:119], v[208:211], v[88:91]
  v_mfma_f32_16x16x32_bf16 v[32:35], v[104:107], v[248:251], v[32:35]
  v_mfma_f32_16x16x32_bf16 v[52:55], v[104:107], v[96:99], v[52:55]
  v_mfma_f32_16x16x32_bf16 v[72:75], v[104:107], v[184:187], v[72:75]
  v_mfma_f32_16x16x32_bf16 v[92:95], v[104:107], v[208:211], v[92:95]
  s_mov_b32 s92, 0x100000
L_lw_15:
  ds_read_b32 v8, v14 offset:0
  s_waitcnt lgkmcnt(0)
  v_cmp_eq_u32 vcc, 0, v8
  s_nop 0
  s_cbranch_vccz L_lwd_16
  s_sleep 1
  s_sub_u32 s92, s92, 1
  s_cmp_lg_u32 s92, 0
  s_cbranch_scc1 L_lw_15
L_lwd_16:
  v_mul_u32_u24 v6, 336, v2
  v_lshl_add_u32 v6, v3, 4, v6
  s_mul_i32 s10, s77, 21504
  v_add_u32 v6, s10, v6
  s_nop 5
  ds_write_b128 v6, v[16:19] offset:0
  ds_write_b128 v6, v[36:39] offset:5376
  ds_write_b128 v6, v[56:59] offset:10752
  ds_write_b128 v6, v[76:79] offset:16128
  ds_write_b128 v6, v[20:23] offset:64
  ds_write_b128 v6, v[40:43] offset:5440
  ds_write_b128 v6, v[60:63] offset:10816
  ds_write_b128 v6, v[80:83] offset:16192
  ds_write_b128 v6, v[24:27] offset:128
  ds_write_b128 v6, v[44:47] offset:5504
  ds_write_b128 v6, v[64:67] offset:10880
  ds_write_b128 v6, v[84:87] offset:16256
  ds_write_b128 v6, v[28:31] offset:192
  ds_write_b128 v6, v[48:51] offset:5568
  ds_write_b128 v6, v[68:71] offset:10944
  ds_write_b128 v6, v[88:91] offset:16320
  ds_write_b128 v6, v[32:35] offset:256
  ds_write_b128 v6, v[52:55] offset:5632
  ds_write_b128 v6, v[72:75] offset:11008
  ds_write_b128 v6, v[92:95] offset:16384
  s_branch L_final
L_H:
  s_lshl_b32 s97, s4, 3
  s_add_u32 s97, s97, s5
  s_sub_u32 s97, s97, 24
  v_lshlrev_b32 v6, 2, v1
  v_add_u32 v6, 157184, v6
  v_mov_b32 v7, 0
  ds_write_b32 v6, v7
  s_lshr_b32 s90, s97, 1
  s_and_b32 s91, s97, 1
  v_lshrrev_b32 v16, 3, v1
  v_mul_u32_u24 v16, 1280, v16
  v_and_b32 v17, 7, v1
  v_lshl_add_u32 v16, v17, 4, v16
  s_mul_i32 s10, s90, 81920
  s_mul_i32 s11, s91, 640
  s_add_u32 s10, s10, s11
  s_min_u32 s13, s3, 4
  s_lshl_b32 s11, s13, 7
  s_add_u32 s11, s11, s10
  v_add_u32 v17, s11, v16
  v_subrev_u32 v17, 10240, v17
  s_mul_i32 s11, s3, 10240
  s_add_u32 s10, s10, s11
  v_add_u32 v16, s10, v16
  s_mul_i32 s13, s13, 17680
  s_mul_i32 s12, s3, 1040
  s_waitcnt lgkmcnt(0)
  s_mov_b32 s60, s18
  s_mov_b32 s61, s19
  s_mov_b32 s62, 0x280000
  s_mov_b32 s63, 0x20000
  s_mov_b32 s64, s20
  s_mov_b32 s65, s21
  s_mov_b32 s66, 0x280000
  s_mov_b32 s67, 0x20000
  s_movk_i32 s11, 0
  s_add_u32 m0, s12, 1040
  s_nop 0
  buffer_load_dwordx4 v16, s[60:63], s11 offen lds
  s_add_u32 m0, s12, 9360
  s_nop 0
  buffer_load_dwordx4 v16, s[64:67], s11 offen lds
  s_movk_i32 s11, 128
  s_add_u32 m0, s12, 18720
  s_nop 0
  buffer_load_dwordx4 v16, s[60:63], s11 offen lds
  s_add_u32 m0, s12, 27040
  s_nop 0
  buffer_load_dwordx4 v16, s[64:67], s11 offen lds
  s_movk_i32 s11, 256
  s_add_u32 m0, s12, 36400
  s_nop 0
  buffer_load_dwordx4 v16, s[60:63], s11 offen lds
  s_add_u32 m0, s12, 44720
  s_nop 0
  buffer_load_dwordx4 v16, s[64:67], s11 offen lds
  s_movk_i32 s11, 384
  s_add_u32 m0, s12, 54080
  s_nop 0
  buffer_load_dwordx4 v16, s[60:63], s11 offen lds
  s_add_u32 m0, s12, 62400
  s_nop 0
  buffer_load_dwordx4 v16, s[64:67], s11 offen lds
  s_movk_i32 s11, 512
  s_add_u32 m0, s12, 71760
  s_nop 0
  buffer_load_dwordx4 v16, s[60:63], s11 offen lds
  s_add_u32 m0, s12, 80080
  s_nop 0
  buffer_load_dwordx4 v16, s[64:67], s11 offen lds
  s_mov_b32 m0, s13
  s_nop 0
  buffer_load_dwordx4 v17, s[60:63], 0 offen lds
  s_mov_b32 s64, s22
  s_mov_b32 s65, s23
  s_mov_b32 s66, 0x1400
  s_mov_b32 s67, 0x20000
  v_lshrrev_b32 v16, 3, v1
  v_lshlrev_b32 v16, 4, v16
  s_mul_i32 s10, s91, 2560
  s_lshl_b32 s11, s3, 7
  s_add_u32 s10, s10, s11
  buffer_load_dwordx4 v[48:51], v16, s[64:67], s10 offen offset:0
  buffer_load_dwordx4 v[52:55], v16, s[64:67], s10 offen offset:1024
  buffer_load_dwordx4 v[56:59], v16, s[64:67], s10 offen offset:2048
  s_mul_i32 s10, s97, 3
  s_add_u32 s10, s10, s3
  s_sub_u32 s10, s10, 5
  s_lshr_b32 s82, s10, 2
  s_and_b32 s10, s10, 3
  s_lshl_b32 s83, s10, 1
  s_mul_i32 s76, s3, 10240
  s_add_u32 s76, s76, 37200
  s_cmp_lt_u32 s3, 5
  s_cbranch_scc1 L_now2
  s_mov_b32 s60, s34
  s_mov_b32 s61, s35
  s_mov_b32 s62, 0x1e0000
  s_mov_b32 s63, 0x20000
  s_mul_i32 s12, s82, 40960
  s_mul_i32 s13, s83, 160
  s_add_u32 s12, s12, s13
  s_add_u32 s13, s12, 160
  v_add_u32 v24, 0, v1
  v_mul_u32_u24 v25, 6554, v24
  v_lshrrev_b32 v25, 16, v25
  v_mul_u32_u24 v26, 10, v25
  v_sub_u32 v26, v24, v26
  v_mul_u32_u24 v25, 1280, v25
  v_lshl_add_u32 v25, v26, 4, v25
  s_add_u32 m0, s76, 0
  s_nop 0
  buffer_load_dwordx4 v25, s[60:63], s12 offen lds
  s_add_u32 m0, s76, 5120
  s_nop 0
  buffer_load_dwordx4 v25, s[60:63], s13 offen lds
  v_add_u32 v24, 64, v1
  v_mul_u32_u24 v25, 6554, v24
  v_lshrrev_b32 v25, 16, v25
  v_mul_u32_u24 v26, 10, v25
  v_sub_u32 v26, v24, v26
  v_mul_u32_u24 v25, 1280, v25
  v_lshl_add_u32 v25, v26, 4, v25
  s_add_u32 m0, s76, 1024
  s_nop 0
  buffer_load_dwordx4 v25, s[60:63], s12 offen lds
  s_add_u32 m0, s76, 6144
  s_nop 0
  buffer_load_dwordx4 v25, s[60:63], s13 offen lds
  v_add_u32 v24, 128, v1
  v_mul_u32_u24 v25, 6554, v24
  v_lshrrev_b32 v25, 16, v25
  v_mul_u32_u24 v26, 10, v25
  v_sub_u32 v26, v24, v26
  v_mul_u32_u24 v25, 1280, v25
  v_lshl_add_u32 v25, v26, 4, v25
  s_add_u32 m0, s76, 2048
  s_nop 0
  buffer_load_dwordx4 v25, s[60:63], s12 offen lds
  s_add_u32 m0, s76, 7168
  s_nop 0
  buffer_load_dwordx4 v25, s[60:63], s13 offen lds
  v_add_u32 v24, 192, v1
  v_mul_u32_u24 v25, 6554, v24
  v_lshrrev_b32 v25, 16, v25
  v_mul_u32_u24 v26, 10, v25
  v_sub_u32 v26, v24, v26
  v_mul_u32_u24 v25, 1280, v25
  v_lshl_add_u32 v25, v26, 4, v25
  s_add_u32 m0, s76, 3072
  s_nop 0
  buffer_load_dwordx4 v25, s[60:63], s12 offen lds
  s_add_u32 m0, s76, 8192
  s_nop 0
  buffer_load_dwordx4 v25, s[60:63], s13 offen lds
  v_add_u32 v24, 256, v1
  v_mul_u32_u24 v25, 6554, v24
  v_lshrrev_b32 v25, 16, v25
  v_mul_u32_u24 v26, 10, v25
  v_sub_u32 v26, v24, v26
  v_mul_u32_u24 v25, 1280, v25
  v_lshl_add_u32 v25, v26, 4, v25
  s_add_u32 m0, s76, 4096
  s_nop 0
  buffer_load_dwordx4 v25, s[60:63], s12 offen lds
  s_add_u32 m0, s76, 9216
  s_nop 0
  buffer_load_dwordx4 v25, s[60:63], s13 offen lds
L_now2:
  s_mov_b32 s56, s44
  s_mov_b32 s57, s45
  s_mov_b32 s58, 0x1000000
  s_mov_b32 s59, 0x20000
  v_and_b32 v16, 7, v1
  v_mul_u32_u24 v16, 1040, v16
  v_lshrrev_b32 v17, 3, v1
  v_lshl_add_u32 v16, v17, 2, v16
  s_lshr_b32 s10, s3, 2
  s_mul_i32 s10, s10, 17680
  s_lshl_b32 s11, s77, 5
  s_add_u32 s10, s10, s11
  v_add_u32 v16, s10, v16
  v_lshlrev_b32 v17, 13, v17
  v_and_b32 v18, 7, v1
  v_lshlrev_b32 v18, 4, v18
  v_sub_u32 v17, v17, v18
  v_add_u32 v17, 112, v17
  v_add_u32 v18, 4096, v17
  s_mul_i32 s10, s91, 20
  s_add_u32 s10, s10, s3
  s_lshl_b32 s11, s10, 12
  s_lshl_b32 s12, s90, 7
  s_add_u32 s11, s11, s12
  s_add_u32 s93, s11, 0x0
  s_lshl_b32 s10, s10, 16
  s_lshl_b32 s11, s90, 7
  s_sub_u32 s10, s10, s11
  s_add_u32 s14, s10, 0x100f80
  s_cmp_lt_u32 s3, 4
  s_cselect_b32 s81, 3, 2
  s_cselect_b32 s86, 7, 3
  s_mov_b32 s87, 0
  s_waitcnt vmcnt(0)
  s_barrier
  ds_read_b32 v64, v16 offset:640
  ds_read_b32 v65, v16 offset:768
  ds_read_b32 v66, v16 offset:896
  ds_read_b32 v67, v16 offset:1040
  ds_read_b32 v68, v16 offset:1168
  ds_read_b32 v69, v16 offset:1296
  ds_read_b32 v70, v16 offset:1424
  ds_read_b32 v71, v16 offset:1552
  ds_read_b32 v72, v16 offset:1680
  ds_read_b32 v73, v16 offset:1808
  ds_read_b32 v74, v16 offset:1936
  ds_read_b32 v76, v16 offset:9360
  ds_read_b32 v77, v16 offset:9488
  ds_read_b32 v78, v16 offset:9616
  ds_read_b32 v79, v16 offset:9744
  ds_read_b32 v80, v16 offset:9872
  ds_read_b32 v81, v16 offset:10000
  ds_read_b32 v82, v16 offset:10128
  ds_read_b32 v83, v16 offset:10256
  v_add_u32 v16, 35360, v16
  s_cmp_lt_u32 s3, 5
  s_cbranch_scc1 L_now2b
  v_lshrrev_b32 v24, 2, v1
  v_mul_u32_u24 v24, 160, v24
  v_and_b32 v25, 3, v1
  v_lshl_add_u32 v24, v25, 3, v24
  v_add_u32 v24, s76, v24
  ds_read_b64_tr_b16 v[160:161], v24 offset:0
  ds_read_b64_tr_b16 v[162:163], v24 offset:2560
  ds_read_b64_tr_b16 v[164:165], v24 offset:32
  ds_read_b64_tr_b16 v[166:167], v24 offset:2592
  ds_read_b64_tr_b16 v[168:169], v24 offset:64
  ds_read_b64_tr_b16 v[170:171], v24 offset:2624
  ds_read_b64_tr_b16 v[172:173], v24 offset:96
  ds_read_b64_tr_b16 v[174:175], v24 offset:2656
  ds_read_b64_tr_b16 v[176:177], v24 offset:128
  ds_read_b64_tr_b16 v[178:179], v24 offset:2688
  ds_read_b64_tr_b16 v[180:181], v24 offset:5120
  ds_read_b64_tr_b16 v[182:183], v24 offset:7680
  ds_read_b64_tr_b16 v[184:185], v24 offset:5152
  ds_read_b64_tr_b16 v[186:187], v24 offset:7712
  ds_read_b64_tr_b16 v[188:189], v24 offset:5184
  ds_read_b64_tr_b16 v[190:191], v24 offset:7744
  ds_read_b64_tr_b16 v[192:193], v24 offset:5216
  ds_read_b64_tr_b16 v[194:195], v24 offset:7776
  ds_read_b64_tr_b16 v[196:197], v24 offset:5248
  ds_read_b64_tr_b16 v[198:199], v24 offset:7808
  s_lshl_b32 s10, s83, 13
  s_lshl_b32 s11, s82, 7
  s_add_u32 s10, s10, s11
  s_add_u32 s96, s10, 0x30000
  s_mul_i32 s10, s83, 48
  s_add_u32 s10, s10, s82
  s_mul_i32 s10, s10, 5120
  s_add_u32 s12, s10, 0x400000
  v_add_u32 v25, 4096, v4
  s_waitcnt lgkmcnt(0)
  buffer_store_dwordx4 v[160:163], v4, s[56:59], s12 offen offset:0 sc1
  buffer_store_dwordx4 v[164:167], v4, s[56:59], s12 offen offset:1024 sc1
  buffer_store_dwordx4 v[168:171], v4, s[56:59], s12 offen offset:2048 sc1
  buffer_store_dwordx4 v[172:175], v4, s[56:59], s12 offen offset:3072 sc1
  buffer_store_dwordx4 v[176:179], v25, s[56:59], s12 offen sc1
  s_add_u32 s12, s12, 245760
  buffer_store_dwordx4 v[180:183], v4, s[56:59], s12 offen offset:0 sc1
  buffer_store_dwordx4 v[184:187], v4, s[56:59], s12 offen offset:1024 sc1
  buffer_store_dwordx4 v[188:191], v4, s[56:59], s12 offen offset:2048 sc1
  buffer_store_dwordx4 v[192:195], v4, s[56:59], s12 offen offset:3072 sc1
  buffer_store_dwordx4 v[196:199], v25, s[56:59], s12 offen sc1
L_now2b:
  v_mov_b32 v6, 0
  global_load_dword v5, v6, s[42:43] sc1
  s_mov_b32 s12, 0x05040100
  s_mov_b32 s13, 0x07060302
L_kv:
  v_lshlrev_b32 v118, 16, v48
  v_lshlrev_b32 v119, 16, v50
  v_and_b32 v120, 0xffff0000, v48
  v_and_b32 v121, 0xffff0000, v50
  v_lshlrev_b32 v122, 16, v49
  v_lshlrev_b32 v123, 16, v51
  v_and_b32 v124, 0xffff0000, v49
  v_and_b32 v125, 0xffff0000, v51
  v_mov_b32 v48, v52
  v_mov_b32 v49, v53
  v_mov_b32 v50, v54
  v_mov_b32 v51, v55
  v_mov_b32 v52, v56
  v_mov_b32 v53, v57
  v_mov_b32 v54, v58
  v_mov_b32 v55, v59
  s_waitcnt lgkmcnt(0)
  v_lshlrev_b32 v96, 16, v64
  v_and_b32 v97, 0xffff0000, v64
  v_lshlrev_b32 v98, 16, v65
  v_and_b32 v99, 0xffff0000, v65
  v_lshlrev_b32 v100, 16, v66
  v_and_b32 v101, 0xffff0000, v66
  v_lshlrev_b32 v102, 16, v67
  v_and_b32 v103, 0xffff0000, v67
  v_lshlrev_b32 v104, 16, v68
  v_and_b32 v105, 0xffff0000, v68
  v_lshlrev_b32 v106, 16, v69
  v_and_b32 v107, 0xffff0000, v69
  v_lshlrev_b32 v108, 16, v70
  v_and_b32 v109, 0xffff0000, v70
  v_lshlrev_b32 v110, 16, v71
  v_and_b32 v111, 0xffff0000, v71
  v_lshlrev_b32 v112, 16, v72
  v_and_b32 v113, 0xffff0000, v72
  v_lshlrev_b32 v114, 16, v73
  v_and_b32 v115, 0xffff0000, v73
  v_lshlrev_b32 v116, 16, v74
  v_and_b32 v117, 0xffff0000, v74
  v_lshlrev_b32 v224, 16, v76
  v_and_b32 v225, 0xffff0000, v76
  v_lshlrev_b32 v226, 16, v77
  v_and_b32 v227, 0xffff0000, v77
  v_lshlrev_b32 v228, 16, v78
  v_and_b32 v229, 0xffff0000, v78
  v_lshlrev_b32 v230, 16, v79
  v_and_b32 v231, 0xffff0000, v79
  v_lshlrev_b32 v232, 16, v80
  v_and_b32 v233, 0xffff0000, v80
  v_lshlrev_b32 v234, 16, v81
  v_and_b32 v235, 0xffff0000, v81
  v_lshlrev_b32 v236, 16, v82
  v_and_b32 v237, 0xffff0000, v82
  v_lshlrev_b32 v238, 16, v83
  v_and_b32 v239, 0xffff0000, v83
  ds_read_b32 v64, v16 offset:640
  ds_read_b32 v65, v16 offset:768
  ds_read_b32 v66, v16 offset:896
  ds_read_b32 v67, v16 offset:1040
  ds_read_b32 v68, v16 offset:1168
  ds_read_b32 v69, v16 offset:1296
  ds_read_b32 v70, v16 offset:1424
  ds_read_b32 v71, v16 offset:1552
  ds_read_b32 v72, v16 offset:1680
  ds_read_b32 v73, v16 offset:1808
  ds_read_b32 v74, v16 offset:1936
  ds_read_b32 v76, v16 offset:9360
  ds_read_b32 v77, v16 offset:9488
  ds_read_b32 v78, v16 offset:9616
  ds_read_b32 v79, v16 offset:9744
  ds_read_b32 v80, v16 offset:9872
  ds_read_b32 v81, v16 offset:10000
  ds_read_b32 v82, v16 offset:10128
  ds_read_b32 v83, v16 offset:10256
  v_add_u32 v16, 35360, v16
  v_pk_mul_f32 v[126:127], v[96:97], v[124:125]
  v_pk_fma_f32 v[126:127], v[98:99], v[122:123], v[126:127]
  v_pk_fma_f32 v[126:127], v[100:101], v[120:121], v[126:127]
  v_pk_fma_f32 v[126:127], v[102:103], v[118:119], v[126:127]
  v_pk_mul_f32 v[126:127], v[126:127], v[224:225]
  v_cvt_pk_bf16_f32 v132, v126, v127
  v_pk_mul_f32 v[126:127], v[98:99], v[124:125]
  v_pk_fma_f32 v[126:127], v[100:101], v[122:123], v[126:127]
  v_pk_fma_f32 v[126:127], v[102:103], v[120:121], v[126:127]
  v_pk_fma_f32 v[126:127], v[104:105], v[118:119], v[126:127]
  v_pk_mul_f32 v[126:127], v[126:127], v[226:227]
  v_cvt_pk_bf16_f32 v133, v126, v127
  v_pk_mul_f32 v[126:127], v[100:101], v[124:125]
  v_pk_fma_f32 v[126:127], v[102:103], v[122:123], v[126:127]
  v_pk_fma_f32 v[126:127], v[104:105], v[120:121], v[126:127]
  v_pk_fma_f32 v[126:127], v[106:107], v[118:119], v[126:127]
  v_pk_mul_f32 v[126:127], v[126:127], v[228:229]
  v_cvt_pk_bf16_f32 v134, v126, v127
  v_pk_mul_f32 v[126:127], v[102:103], v[124:125]
  v_pk_fma_f32 v[126:127], v[104:105], v[122:123], v[126:127]
  v_pk_fma_f32 v[126:127], v[106:107], v[120:121], v[126:127]
  v_pk_fma_f32 v[126:127], v[108:109], v[118:119], v[126:127]
  v_pk_mul_f32 v[126:127], v[126:127], v[230:231]
  v_cvt_pk_bf16_f32 v135, v126, v127
  v_pk_mul_f32 v[126:127], v[104:105], v[124:125]
  v_pk_fma_f32 v[126:127], v[106:107], v[122:123], v[126:127]
  v_pk_fma_f32 v[126:127], v[108:109], v[120:121], v[126:127]
  v_pk_fma_f32 v[126:127], v[110:111], v[118:119], v[126:127]
  v_pk_mul_f32 v[126:127], v[126:127], v[232:233]
  v_cvt_pk_bf16_f32 v136, v126, v127
  v_pk_mul_f32 v[126:127], v[106:107], v[124:125]
  v_pk_fma_f32 v[126:127], v[108:109], v[122:123], v[126:127]
  v_pk_fma_f32 v[126:127], v[110:111], v[120:121], v[126:127]
  v_pk_fma_f32 v[126:127], v[112:113], v[118:119], v[126:127]
  v_pk_mul_f32 v[126:127], v[126:127], v[234:235]
  v_cvt_pk_bf16_f32 v137, v126, v127
  v_pk_mul_f32 v[126:127], v[108:109], v[124:125]
  v_pk_fma_f32 v[126:127], v[110:111], v[122:123], v[126:127]
  v_pk_fma_f32 v[126:127], v[112:113], v[120:121], v[126:127]
  v_pk_fma_f32 v[126:127], v[114:115], v[118:119], v[126:127]
  v_pk_mul_f32 v[126:127], v[126:127], v[236:237]
  v_cvt_pk_bf16_f32 v138, v126, v127
  v_pk_mul_f32 v[126:127], v[110:111], v[124:125]
  v_pk_fma_f32 v[126:127], v[112:113], v[122:123], v[126:127]
  v_pk_fma_f32 v[126:127], v[114:115], v[120:121], v[126:127]
  v_pk_fma_f32 v[126:127], v[116:117], v[118:119], v[126:127]
  v_pk_mul_f32 v[126:127], v[126:127], v[238:239]
  v_cvt_pk_bf16_f32 v139, v126, v127
  v_perm_b32 v140, v138, v139, s12
  v_perm_b32 v141, v136, v137, s12
  v_perm_b32 v142, v134, v135, s12
  v_perm_b32 v143, v132, v133, s12
  v_perm_b32 v144, v138, v139, s13
  v_perm_b32 v145, v136, v137, s13
  v_perm_b32 v146, v134, v135, s13
  v_perm_b32 v147, v132, v133, s13
  buffer_store_dwordx4 v[140:143], v17, s[56:59], s14 offen sc1
  buffer_store_dwordx4 v[144:147], v18, s[56:59], s14 offen sc1
  s_add_u32 s14, s14, 524288
  s_sub_u32 s81, s81, 1
  s_cmp_lg_u32 s81, 0
  s_cbranch_scc1 L_kv
  s_waitcnt vmcnt(0) lgkmcnt(0)
  v_cmp_eq_u32 vcc, 0, v5
  s_nop 0
  s_cbranch_vccz L_h_tag
  s_mov_b32 s92, 0x40000
  v_mov_b32 v6, 0
L_nct_17:
  global_load_dword v5, v6, s[42:43] sc1
  s_waitcnt vmcnt(0)
  v_cmp_eq_u32 vcc, 0, v5
  s_nop 0
  s_cbranch_vccz L_ncd_18
  s_sleep 2
  s_sub_u32 s92, s92, 1
  s_cmp_lg_u32 s92, 0
  s_cbranch_scc1 L_nct_17
L_ncd_18:
L_h_tag:
  v_lshlrev_b32 v6, 15, v1
  s_mov_b64 exec, s[86:87]
  buffer_store_dword v5, v6, s[56:59], s93 offen sc1
  s_mov_b64 exec, -1
  s_cmp_lt_u32 s3, 5
  s_cbranch_scc1 L_nofwf
  v_lshlrev_b32 v6, 13, v1
  s_mov_b64 exec, 3
  buffer_store_dword v5, v6, s[56:59], s96 offen sc1
  s_mov_b64 exec, -1
L_nofwf:
  s_lshl_b32 s84, s97, 2
  s_add_u32 s84, s84, s77
  s_cmp_lt_u32 s3, 4
  s_cbranch_scc1 L_nohh
  s_mov_b32 s68, s24
  s_mov_b32 s69, s25
  s_mov_b32 s70, 0x280000
  s_mov_b32 s71, 0x20000
  s_lshl_b32 s10, s84, 12
  buffer_load_dwordx4 v[128:131], v4, s[68:71], s10 offen offset:0
  buffer_load_dwordx2 v[192:193], v4, s[68:71], s10 offen offset:16
  buffer_load_dwordx4 v[132:135], v4, s[68:71], s10 offen offset:1024
  buffer_load_dwordx2 v[194:195], v4, s[68:71], s10 offen offset:1040
  buffer_load_dwordx4 v[136:139], v4, s[68:71], s10 offen offset:2048
  buffer_load_dwordx2 v[196:197], v4, s[68:71], s10 offen offset:2064
  buffer_load_dwordx4 v[140:143], v4, s[68:71], s10 offen offset:3072
  buffer_load_dwordx2 v[198:199], v4, s[68:71], s10 offen offset:3088
  s_lshl_b32 s10, s84, 1
  v_mov_b32 v6, s10
  global_load_ushort v15, v6, s[26:27]
L_nohh:
  s_barrier
  s_cmp_eq_u32 s77, 0
  s_cselect_b32 s98, 104448, s98
  s_cselect_b32 s85, 0, s85
  s_cmp_eq_u32 s77, 1
  s_cselect_b32 s98, 157696, s98
  s_cselect_b32 s85, 43008, s85
  s_cmp_eq_u32 s77, 2
  s_cselect_b32 s98, 114688, s98
  s_cselect_b32 s85, 114688, s85
  s_cmp_eq_u32 s77, 3
  s_cselect_b32 s98, 135936, s98
  s_cselect_b32 s85, 135936, s85
  v_and_b32 v14, 1, v1
  v_lshlrev_b32 v14, 2, v14
  v_add_u32 v14, 157296, v14
  s_cmp_ge_u32 s3, 4
  s_cbranch_scc1 L_conv
  v_min_u32 v10, 47, v1
  v_lshlrev_b32 v10, 7, v10
  s_lshl_b32 s15, s9, 13
  s_add_u32 s15, s15, 0x30000
  v_mov_b32 v7, 157184
  s_cmp_lg_u32 s3, 0
  s_cbranch_scc1 L_hfw
  s_mov_b32 s92, 0x40000
L_poll_19:
  buffer_load_dword v11, v10, s[56:59], s15 offen sc1
  s_waitcnt vmcnt(0)
  v_cmp_ne_u32 vcc, v11, v5
  s_nop 0
  s_cbranch_vccz L_pdone_20
  s_sleep 16
  s_sub_u32 s92, s92, 1
  s_cmp_lg_u32 s92, 0
  s_cbranch_scc1 L_poll_19
L_pdone_20:
  ds_write_b32 v7, v5 offset:8
L_hfw:
  s_mov_b32 s92, 0x100000
L_lw_21:
  ds_read_b32 v8, v7 offset:8
  s_waitcnt lgkmcnt(0)
  v_cmp_ne_u32 vcc, v5, v8
  s_nop 0
  s_cbranch_vccz L_lwd_22
  s_sleep 4
  s_sub_u32 s92, s92, 1
  s_cmp_lg_u32 s92, 0
  s_cbranch_scc1 L_lw_21
L_lwd_22:
  s_branch L_fwok
L_cv7:
  s_cmp_eq_u32 s78, 1
  s_cbranch_scc1 L_havexr
  v_and_b32 v6, 31, v1
  v_lshlrev_b32 v6, 7, v6
  s_lshr_b32 s10, s84, 4
  s_lshl_b32 s10, s10, 12
  s_add_u32 s10, s10, 0x0
  s_mov_b32 s92, 0x40000
L_poll_23:
  buffer_load_dword v7, v6, s[56:59], s10 offen sc1
  s_waitcnt vmcnt(0)
  v_cmp_ne_u32 vcc, v7, v5
  s_nop 0
  s_cbranch_vccz L_pdone_24
  s_sleep 4
  s_sub_u32 s92, s92, 1
  s_cmp_lg_u32 s92, 0
  s_cbranch_scc1 L_poll_23
L_pdone_24:
  s_lshl_b32 s10, s84, 12
  s_add_u32 s10, s10, 0x100000
  buffer_load_dwordx4 v[96:99], v4, s[56:59], s10 offen offset:0 sc1
  buffer_load_dwordx4 v[100:103], v4, s[56:59], s10 offen offset:1024 sc1
  buffer_load_dwordx4 v[104:107], v4, s[56:59], s10 offen offset:2048 sc1
  buffer_load_dwordx4 v[108:111], v4, s[56:59], s10 offen offset:3072 sc1
  s_waitcnt vmcnt(0)
L_havexr:
  v_mov_b32 v7, 157188
  s_mov_b32 s92, 0x100000
L_lw_25:
  ds_read_b32 v6, v7 offset:0
  s_waitcnt lgkmcnt(0)
  v_cmp_ne_u32 vcc, 8, v6
  s_nop 0
  s_cbranch_vccz L_lwd_26
  s_sub_u32 s92, s92, 1
  s_cmp_lg_u32 s92, 0
  s_cbranch_scc1 L_lw_25
L_lwd_26:
  v_add_u32 v10, s85, v4
  ds_write_b128 v10, v[96:99] offset:16640
  ds_write_b128 v10, v[100:103] offset:17664
  ds_write_b128 v10, v[104:107] offset:18688
  ds_write_b128 v10, v[108:111] offset:19712
  s_lshl_b32 s10, s99, 3
  s_add_u32 s10, s10, 157200
  v_mov_b32 v7, s10
  v_mov_b32 v6, 1
  ds_write_b32 v7, v6
  s_mov_b32 s15, 0
  s_branch L_cvgo
L_cv6:
  s_lshl_b32 s10, s99, 3
  s_add_u32 s10, s10, 157200
  v_mov_b32 v7, s10
  s_mov_b32 s92, 0x100000
L_lw_27:
  ds_read_b32 v6, v7 offset:0
  s_waitcnt lgkmcnt(0)
  v_cmp_eq_u32 vcc, 0, v6
  s_nop 0
  s_cbranch_vccz L_lwd_28
  s_sleep 1
  s_sub_u32 s92, s92, 1
  s_cmp_lg_u32 s92, 0
  s_cbranch_scc1 L_lw_27
L_lwd_28:
  s_movk_i32 s15, 256
  s_branch L_cvgo
L_conv:
  s_setprio 1
  v_and_b32 v6, 31, v1
  v_lshlrev_b32 v6, 7, v6
  s_lshr_b32 s10, s84, 4
  s_lshl_b32 s10, s10, 12
  s_add_u32 s10, s10, 0x0
  s_mov_b32 s92, 0x40000
L_poll_29:
  buffer_load_dword v7, v6, s[56:59], s10 offen sc1
  s_waitcnt vmcnt(0)
  v_cmp_ne_u32 vcc, v7, v5
  s_nop 0
  s_cbranch_vccz L_pdone_30
  s_sleep 4
  s_sub_u32 s92, s92, 1
  s_cmp_lg_u32 s92, 0
  s_cbranch_scc1 L_poll_29
L_pdone_30:
  s_lshl_b32 s10, s84, 12
  s_add_u32 s10, s10, 0x100000
  buffer_load_dwordx4 v[96:99], v4, s[56:59], s10 offen offset:0 sc1
  buffer_load_dwordx4 v[100:103], v4, s[56:59], s10 offen offset:1024 sc1
  buffer_load_dwordx4 v[104:107], v4, s[56:59], s10 offen offset:2048 sc1
  buffer_load_dwordx4 v[108:111], v4, s[56:59], s10 offen offset:3072 sc1
  v_add_u32 v10, s85, v4
  v_alignbit_b32 v144, v129, v128, 16
  v_mov_b32 v160, v129
  v_alignbit_b32 v176, v130, v129, 16
  v_alignbit_b32 v145, v130, v129, 16
  v_mov_b32 v161, v130
  v_alignbit_b32 v177, v131, v130, 16
  v_alignbit_b32 v146, v131, v130, 16
  v_mov_b32 v162, v131
  v_alignbit_b32 v178, v192, v131, 16
  v_alignbit_b32 v147, v192, v131, 16
  v_mov_b32 v163, v192
  v_alignbit_b32 v179, v193, v192, 16
  ds_write_b128 v10, v[128:131] offset:32
  ds_write_b128 v10, v[144:147] offset:4192
  ds_write_b128 v10, v[160:163] offset:8352
  ds_write_b128 v10, v[176:179] offset:12512
  v_alignbit_b32 v148, v133, v132, 16
  v_mov_b32 v164, v133
  v_alignbit_b32 v180, v134, v133, 16
  v_alignbit_b32 v149, v134, v133, 16
  v_mov_b32 v165, v134
  v_alignbit_b32 v181, v135, v134, 16
  v_alignbit_b32 v150, v135, v134, 16
  v_mov_b32 v166, v135
  v_alignbit_b32 v182, v194, v135, 16
  v_alignbit_b32 v151, v194, v135, 16
  v_mov_b32 v167, v194
  v_alignbit_b32 v183, v195, v194, 16
  ds_write_b128 v10, v[132:135] offset:1056
  ds_write_b128 v10, v[148:151] offset:5216
  ds_write_b128 v10, v[164:167] offset:9376
  ds_write_b128 v10, v[180:183] offset:13536
  v_alignbit_b32 v152, v137, v136, 16
  v_mov_b32 v168, v137
  v_alignbit_b32 v184, v138, v137, 16
  v_alignbit_b32 v153, v138, v137, 16
  v_mov_b32 v169, v138
  v_alignbit_b32 v185, v139, v138, 16
  v_alignbit_b32 v154, v139, v138, 16
  v_mov_b32 v170, v139
  v_alignbit_b32 v186, v196, v139, 16
  v_alignbit_b32 v155, v196, v139, 16
  v_mov_b32 v171, v196
  v_alignbit_b32 v187, v197, v196, 16
  ds_write_b128 v10, v[136:139] offset:2080
  ds_write_b128 v10, v[152:155] offset:6240
  ds_write_b128 v10, v[168:171] offset:10400
  ds_write_b128 v10, v[184:187] offset:14560
  v_alignbit_b32 v156, v141, v140, 16
  v_mov_b32 v172, v141
  v_alignbit_b32 v188, v142, v141, 16
  v_alignbit_b32 v157, v142, v141, 16
  v_mov_b32 v173, v142
  v_alignbit_b32 v189, v143, v142, 16
  v_alignbit_b32 v158, v143, v142, 16
  v_mov_b32 v174, v143
  v_alignbit_b32 v190, v198, v143, 16
  v_alignbit_b32 v159, v198, v143, 16
  v_mov_b32 v175, v198
  v_alignbit_b32 v191, v199, v198, 16
  ds_write_b128 v10, v[140:143] offset:3104
  ds_write_b128 v10, v[156:159] offset:7264
  ds_write_b128 v10, v[172:175] offset:11424
  ds_write_b128 v10, v[188:191] offset:15584
  v_mov_b32 v20, 0
  v_mov_b32 v21, 0
  v_mov_b32 v22, 0
  v_mov_b32 v23, 0
  s_mov_b64 exec, 0x3fffffff
  ds_write_b128 v10, v[20:23] offset:20736
  s_mov_b64 exec, 3
  ds_write_b128 v10, v[20:23] offset:0
  ds_write_b128 v10, v[20:23] offset:4160
  ds_write_b128 v10, v[20:23] offset:8320
  ds_write_b128 v10, v[20:23] offset:12480
  s_mov_b64 exec, 1
  v_lshlrev_b32 v24, 16, v128
  ds_write_b32 v10, v24 offset:4188
  ds_write_b32 v10, v128 offset:8348
  ds_write_b32 v10, v24 offset:12504
  ds_write_b32 v10, v144 offset:12508
  s_mov_b64 exec, -1
  s_waitcnt vmcnt(0)
  v_add_u32 v10, s85, v4
  ds_write_b128 v10, v[96:99] offset:16640
  ds_write_b128 v10, v[100:103] offset:17664
  ds_write_b128 v10, v[104:107] offset:18688
  ds_write_b128 v10, v[108:111] offset:19712
  s_mov_b32 s81, 4
  s_mov_b32 s15, 0
L_cvgo:
  s_add_u32 s15, s15, s85
  v_lshl_add_u32 v12, v3, 3, v2
  v_add_u32 v12, 1, v12
  v_and_b32 v11, 3, v12
  v_sub_u32 v12, v12, v11
  v_lshlrev_b32 v12, 1, v12
  v_mul_u32_u24 v11, 4160, v11
  v_add3_u32 v8, v12, v11, s15
  v_lshlrev_b32 v12, 5, v2
  v_lshlrev_b32 v11, 4, v3
  v_sub_u32 v12, v11, v12
  v_add_u32 v12, 17120, v12
  v_add_u32 v9, s15, v12
  s_waitcnt lgkmcnt(0)
  v_mov_b32 v16, 0
  v_mov_b32 v17, 0
  v_mov_b32 v18, 0
  v_mov_b32 v19, 0
  v_mov_b32 v20, 0
  v_mov_b32 v21, 0
  v_mov_b32 v22, 0
  v_mov_b32 v23, 0
  v_mov_b32 v24, 0
  v_mov_b32 v25, 0
  v_mov_b32 v26, 0
  v_mov_b32 v27, 0
  v_mov_b32 v28, 0
  v_mov_b32 v29, 0
  v_mov_b32 v30, 0
  v_mov_b32 v31, 0
  v_mov_b32 v32, 0
  v_mov_b32 v33, 0
  v_mov_b32 v34, 0
  v_mov_b32 v35, 0
  v_mov_b32 v36, 0
  v_mov_b32 v37, 0
  v_mov_b32 v38, 0
  v_mov_b32 v39, 0
  v_mov_b32 v40, 0
  v_mov_b32 v41, 0
  v_mov_b32 v42, 0
  v_mov_b32 v43, 0
  v_mov_b32 v44, 0
  v_mov_b32 v45, 0
  v_mov_b32 v46, 0
  v_mov_b32 v47, 0
  ds_read_b64 v[64:65], v8 offset:0
  ds_read_b64 v[66:67], v8 offset:8
  ds_read_b128 v[96:99], v9 offset:3584
  ds_read_b64 v[68:69], v8 offset:512
  ds_read_b64 v[70:71], v8 offset:520
  ds_read_b128 v[100:103], v9 offset:3072
  ds_read_b64 v[72:73], v8 offset:1024
  ds_read_b64 v[74:75], v8 offset:1032
  ds_read_b128 v[104:107], v9 offset:2560
  ds_read_b64 v[76:77], v8 offset:1536
  ds_read_b64 v[78:79], v8 offset:1544
  ds_read_b128 v[108:111], v9 offset:2048
  ds_read_b64 v[80:81], v8 offset:2048
  ds_read_b64 v[82:83], v8 offset:2056
  ds_read_b128 v[112:115], v9 offset:1536
  ds_read_b64 v[84:85], v8 offset:2560
  ds_read_b64 v[86:87], v8 offset:2568
  ds_read_b128 v[116:119], v9 offset:1024
  ds_read_b64 v[88:89], v8 offset:3072
  ds_read_b64 v[90:91], v8 offset:3080
  ds_read_b128 v[120:123], v9 offset:512
  ds_read_b64 v[92:93], v8 offset:3584
  ds_read_b64 v[94:95], v8 offset:3592
  ds_read_b128 v[124:127], v9 offset:0
  s_waitcnt lgkmcnt(0)
L_cv:
  ds_read_b64 v[128:129], v8 offset:64
  v_mfma_f32_16x16x32_bf16 v[16:19], v[64:67], v[96:99], v[16:19]
  ds_read_b64 v[130:131], v8 offset:72
  v_mfma_f32_16x16x32_bf16 v[20:23], v[64:67], v[100:103], v[20:23]
  ds_read_b128 v[160:163], v9 offset:3648
  v_mfma_f32_16x16x32_bf16 v[24:27], v[64:67], v[104:107], v[24:27]
  ds_read_b64 v[132:133], v8 offset:576
  v_mfma_f32_16x16x32_bf16 v[28:31], v[64:67], v[108:111], v[28:31]
  ds_read_b64 v[134:135], v8 offset:584
  v_mfma_f32_16x16x32_bf16 v[32:35], v[64:67], v[112:115], v[32:35]
  ds_read_b128 v[164:167], v9 offset:3136
  v_mfma_f32_16x16x32_bf16 v[36:39], v[64:67], v[116:119], v[36:39]
  ds_read_b64 v[136:137], v8 offset:1088
  v_mfma_f32_16x16x32_bf16 v[40:43], v[64:67], v[120:123], v[40:43]
  ds_read_b64 v[138:139], v8 offset:1096
  v_mfma_f32_16x16x32_bf16 v[44:47], v[64:67], v[124:127], v[44:47]
  ds_read_b128 v[168:171], v9 offset:2624
  v_mfma_f32_16x16x32_bf16 v[20:23], v[68:71], v[96:99], v[20:23]
  ds_read_b64 v[140:141], v8 offset:1600
  v_mfma_f32_16x16x32_bf16 v[24:27], v[68:71], v[100:103], v[24:27]
  ds_read_b64 v[142:143], v8 offset:1608
  v_mfma_f32_16x16x32_bf16 v[28:31], v[68:71], v[104:107], v[28:31]
  ds_read_b128 v[172:175], v9 offset:2112
  v_mfma_f32_16x16x32_bf16 v[32:35], v[68:71], v[108:111], v[32:35]
  ds_read_b64 v[144:145], v8 offset:2112
  v_mfma_f32_16x16x32_bf16 v[36:39], v[68:71], v[112:115], v[36:39]
  ds_read_b64 v[146:147], v8 offset:2120
  v_mfma_f32_16x16x32_bf16 v[40:43], v[68:71], v[116:119], v[40:43]
  ds_read_b128 v[176:179], v9 offset:1600
  v_mfma_f32_16x16x32_bf16 v[44:47], v[68:71], v[120:123], v[44:47]
  ds_read_b64 v[148:149], v8 offset:2624
  v_mfma_f32_16x16x32_bf16 v[24:27], v[72:75], v[96:99], v[24:27]
  ds_read_b64 v[150:151], v8 offset:2632
  v_mfma_f32_16x16x32_bf16 v[28:31], v[72:75], v[100:103], v[28:31]
  ds_read_b128 v[180:183], v9 offset:1088
  v_mfma_f32_16x16x32_bf16 v[32:35], v[72:75], v[104:107], v[32:35]
  ds_read_b64 v[152:153], v8 offset:3136
  v_mfma_f32_16x16x32_bf16 v[36:39], v[72:75], v[108:111], v[36:39]
  ds_read_b64 v[154:155], v8 offset:3144
  v_mfma_f32_16x16x32_bf16 v[40:43], v[72:75], v[112:115], v[40:43]
  ds_read_b128 v[184:187], v9 offset:576
  v_mfma_f32_16x16x32_bf16 v[44:47], v[72:75], v[116:119], v[44:47]
  ds_read_b64 v[156:157], v8 offset:3648
  v_mfma_f32_16x16x32_bf16 v[28:31], v[76:79], v[96:99], v[28:31]
  ds_read_b64 v[158:159], v8 offset:3656
  v_mfma_f32_16x16x32_bf16 v[32:35], v[76:79], v[100:103], v[32:35]
  ds_read_b128 v[188:191], v9 offset:64
  v_mfma_f32_16x16x32_bf16 v[36:39], v[76:79], v[104:107], v[36:39]
  v_mfma_f32_16x16x32_bf16 v[40:43], v[76:79], v[108:111], v[40:43]
  v_mfma_f32_16x16x32_bf16 v[44:47], v[76:79], v[112:115], v[44:47]
  v_mfma_f32_16x16x32_bf16 v[32:35], v[80:83], v[96:99], v[32:35]
  v_mfma_f32_16x16x32_bf16 v[36:39], v[80:83], v[100:103], v[36:39]
  v_mfma_f32_16x16x32_bf16 v[40:43], v[80:83], v[104:107], v[40:43]
  v_mfma_f32_16x16x32_bf16 v[44:47], v[80:83], v[108:111], v[44:47]
  v_mfma_f32_16x16x32_bf16 v[36:39], v[84:87], v[96:99], v[36:39]
  v_mfma_f32_16x16x32_bf16 v[40:43], v[84:87], v[100:103], v[40:43]
  v_mfma_f32_16x16x32_bf16 v[44:47], v[84:87], v[104:107], v[44:47]
  v_mfma_f32_16x16x32_bf16 v[40:43], v[88:91], v[96:99], v[40:43]
  v_mfma_f32_16x16x32_bf16 v[44:47], v[88:91], v[100:103], v[44:47]
  v_mfma_f32_16x16x32_bf16 v[44:47], v[92:95], v[96:99], v[44:47]
  s_waitcnt lgkmcnt(0)
  ds_read_b64 v[64:65], v8 offset:128
  v_mfma_f32_16x16x32_bf16 v[16:19], v[128:131], v[160:163], v[16:19]
  ds_read_b64 v[66:67], v8 offset:136
  v_mfma_f32_16x16x32_bf16 v[20:23], v[128:131], v[164:167], v[20:23]
  ds_read_b128 v[96:99], v9 offset:3712
  v_mfma_f32_16x16x32_bf16 v[24:27], v[128:131], v[168:171], v[24:27]
  ds_read_b64 v[68:69], v8 offset:640
  v_mfma_f32_16x16x32_bf16 v[28:31], v[128:131], v[172:175], v[28:31]
  ds_read_b64 v[70:71], v8 offset:648
  v_mfma_f32_16x16x32_bf16 v[32:35], v[128:131], v[176:179], v[32:35]
  ds_read_b128 v[100:103], v9 offset:3200
  v_mfma_f32_16x16x32_bf16 v[36:39], v[128:131], v[180:183], v[36:39]
  ds_read_b64 v[72:73], v8 offset:1152
  v_mfma_f32_16x16x32_bf16 v[40:43], v[128:131], v[184:187], v[40:43]
  ds_read_b64 v[74:75], v8 offset:1160
  v_mfma_f32_16x16x32_bf16 v[44:47], v[128:131], v[188:191], v[44:47]
  ds_read_b128 v[104:107], v9 offset:2688
  v_mfma_f32_16x16x32_bf16 v[20:23], v[132:135], v[160:163], v[20:23]
  ds_read_b64 v[76:77], v8 offset:1664
  v_mfma_f32_16x16x32_bf16 v[24:27], v[132:135], v[164:167], v[24:27]
  ds_read_b64 v[78:79], v8 offset:1672
  v_mfma_f32_16x16x32_bf16 v[28:31], v[132:135], v[168:171], v[28:31]
  ds_read_b128 v[108:111], v9 offset:2176
  v_mfma_f32_16x16x32_bf16 v[32:35], v[132:135], v[172:175], v[32:35]
  ds_read_b64 v[80:81], v8 offset:2176
  v_mfma_f32_16x16x32_bf16 v[36:39], v[132:135], v[176:179], v[36:39]
  ds_read_b64 v[82:83], v8 offset:2184
  v_mfma_f32_16x16x32_bf16 v[40:43], v[132:135], v[180:183], v[40:43]
  ds_read_b128 v[112:115], v9 offset:1664
  v_mfma_f32_16x16x32_bf16 v[44:47], v[132:135], v[184:187], v[44:47]
  ds_read_b64 v[84:85], v8 offset:2688
  v_mfma_f32_16x16x32_bf16 v[24:27], v[136:139], v[160:163], v[24:27]
  ds_read_b64 v[86:87], v8 offset:2696
  v_mfma_f32_16x16x32_bf16 v[28:31], v[136:139], v[164:167], v[28:31]
  ds_read_b128 v[116:119], v9 offset:1152
  v_mfma_f32_16x16x32_bf16 v[32:35], v[136:139], v[168:171], v[32:35]
  ds_read_b64 v[88:89], v8 offset:3200
  v_mfma_f32_16x16x32_bf16 v[36:39], v[136:139], v[172:175], v[36:39]
  ds_read_b64 v[90:91], v8 offset:3208
  v_mfma_f32_16x16x32_bf16 v[40:43], v[136:139], v[176:179], v[40:43]
  ds_read_b128 v[120:123], v9 offset:640
  v_mfma_f32_16x16x32_bf16 v[44:47], v[136:139], v[180:183], v[44:47]
  ds_read_b64 v[92:93], v8 offset:3712
  v_mfma_f32_16x16x32_bf16 v[28:31], v[140:143], v[160:163], v[28:31]
  ds_read_b64 v[94:95], v8 offset:3720
  v_mfma_f32_16x16x32_bf16 v[32:35], v[140:143], v[164:167], v[32:35]
  ds_read_b128 v[124:127], v9 offset:128
  v_mfma_f32_16x16x32_bf16 v[36:39], v[140:143], v[168:171], v[36:39]
  v_mfma_f32_16x16x32_bf16 v[40:43], v[140:143], v[172:175], v[40:43]
  v_mfma_f32_16x16x32_bf16 v[44:47], v[140:143], v[176:179], v[44:47]
  v_mfma_f32_16x16x32_bf16 v[32:35], v[144:147], v[160:163], v[32:35]
  v_mfma_f32_16x16x32_bf16 v[36:39], v[144:147], v[164:167], v[36:39]
  v_mfma_f32_16x16x32_bf16 v[40:43], v[144:147], v[168:171], v[40:43]
  v_mfma_f32_16x16x32_bf16 v[44:47], v[144:147], v[172:175], v[44:47]
  v_mfma_f32_16x16x32_bf16 v[36:39], v[148:151], v[160:163], v[36:39]
  v_mfma_f32_16x16x32_bf16 v[40:43], v[148:151], v[164:167], v[40:43]
  v_mfma_f32_16x16x32_bf16 v[44:47], v[148:151], v[168:171], v[44:47]
  v_mfma_f32_16x16x32_bf16 v[40:43], v[152:155], v[160:163], v[40:43]
  v_mfma_f32_16x16x32_bf16 v[44:47], v[152:155], v[164:167], v[44:47]
  v_mfma_f32_16x16x32_bf16 v[44:47], v[156:159], v[160:163], v[44:47]
  v_add_u32 v8, 128, v8
  v_add_u32 v9, 128, v9
  s_sub_u32 s81, s81, 1
  s_cmp_lg_u32 s81, 0
  s_waitcnt lgkmcnt(0)
  s_cbranch_scc1 L_cv
  s_setprio 3
  s_cmp_ge_u32 s5, 24
  s_cbranch_scc1 L_cvepi
  s_lshl_b32 s10, s99, 13
  s_add_u32 s10, s10, 86016
  v_add_u32 v10, s10, v4
  s_and_b32 s10, s3, 1
  s_cmp_eq_u32 s10, 1
  s_cbranch_scc1 L_cvadd
  v_and_b32 v11, 3, v1
  v_lshlrev_b32 v11, 2, v11
  v_add_u32 v11, 157248, v11
  s_mov_b32 s92, 0x100000
L_lw_31:
  ds_read_b32 v6, v11 offset:0
  s_waitcnt lgkmcnt(0)
  v_cmp_gt_u32 vcc, 2, v6
  s_nop 0
  s_cbranch_vccz L_lwd_32
  s_sub_u32 s92, s92, 1
  s_cmp_lg_u32 s92, 0
  s_cbranch_scc1 L_lw_31
L_lwd_32:
  ds_write_b128 v10, v[16:19] offset:0
  ds_write_b128 v10, v[20:23] offset:1024
  ds_write_b128 v10, v[24:27] offset:2048
  ds_write_b128 v10, v[28:31] offset:3072
  ds_write_b128 v10, v[32:35] offset:4096
  ds_write_b128 v10, v[36:39] offset:5120
  ds_write_b128 v10, v[40:43] offset:6144
  ds_write_b128 v10, v[44:47] offset:7168
  v_mov_b32 v6, 1
  ds_write_b32 v7, v6 offset:4
  s_branch L_preepi
L_cvadd:
  s_mov_b32 s92, 0x100000
L_lw_33:
  ds_read_b32 v6, v7 offset:4
  s_waitcnt lgkmcnt(0)
  v_cmp_eq_u32 vcc, 0, v6
  s_nop 0
  s_cbranch_vccz L_lwd_34
  s_sub_u32 s92, s92, 1
  s_cmp_lg_u32 s92, 0
  s_cbranch_scc1 L_lw_33
L_lwd_34:
  ds_read_b128 v[64:67], v10 offset:0
  ds_read_b128 v[68:71], v10 offset:1024
  ds_read_b128 v[72:75], v10 offset:2048
  ds_read_b128 v[76:79], v10 offset:3072
  ds_read_b128 v[80:83], v10 offset:4096
  ds_read_b128 v[84:87], v10 offset:5120
  ds_read_b128 v[88:91], v10 offset:6144
  ds_read_b128 v[92:95], v10 offset:7168
  s_waitcnt lgkmcnt(0)
  v_add_f32 v16, v16, v64
  v_add_f32 v17, v17, v65
  v_add_f32 v18, v18, v66
  v_add_f32 v19, v19, v67
  v_add_f32 v20, v20, v68
  v_add_f32 v21, v21, v69
  v_add_f32 v22, v22, v70
  v_add_f32 v23, v23, v71
  v_add_f32 v24, v24, v72
  v_add_f32 v25, v25, v73
  v_add_f32 v26, v26, v74
  v_add_f32 v27, v27, v75
  v_add_f32 v28, v28, v76
  v_add_f32 v29, v29, v77
  v_add_f32 v30, v30, v78
  v_add_f32 v31, v31, v79
  v_add_f32 v32, v32, v80
  v_add_f32 v33, v33, v81
  v_add_f32 v34, v34, v82
  v_add_f32 v35, v35, v83
  v_add_f32 v36, v36, v84
  v_add_f32 v37, v37, v85
  v_add_f32 v38, v38, v86
  v_add_f32 v39, v39, v87
  v_add_f32 v40, v40, v88
  v_add_f32 v41, v41, v89
  v_add_f32 v42, v42, v90
  v_add_f32 v43, v43, v91
  v_add_f32 v44, v44, v92
  v_add_f32 v45, v45, v93
  v_add_f32 v46, v46, v94
  v_add_f32 v47, v47, v95
L_cvepi:
  v_lshlrev_b32 v10, 5, v2
  v_lshl_add_u32 v10, v3, 3, v10
  v_sub_u32 v11, 17144, v10
  v_add_u32 v11, s85, v11
  v_add_u32 v10, s85, v10
  ds_read_b64 v[64:65], v11 offset:3584
  ds_read_b64 v[66:67], v11 offset:3072
  ds_read_b64 v[68:69], v11 offset:2560
  ds_read_b64 v[70:71], v11 offset:2048
  ds_read_b64 v[72:73], v11 offset:1536
  ds_read_b64 v[74:75], v11 offset:1024
  ds_read_b64 v[76:77], v11 offset:512
  ds_read_b64 v[78:79], v11 offset:0
  v_lshlrev_b32 v12, 16, v15
  v_mov_b32 v13, v12
  s_waitcnt lgkmcnt(0)
  v_and_b32 v96, 0xffff0000, v65
  v_lshlrev_b32 v97, 16, v65
  v_and_b32 v98, 0xffff0000, v64
  v_lshlrev_b32 v99, 16, v64
  v_fma_f32 v16, v96, v12, v16
  v_fma_f32 v17, v97, v13, v17
  v_fma_f32 v18, v98, v12, v18
  v_fma_f32 v19, v99, v13, v19
  v_cvt_pk_bf16_f32 v64, v16, v17
  v_cvt_pk_bf16_f32 v65, v18, v19
  ds_write_b64 v10, v[64:65] offset:0
  v_and_b32 v96, 0xffff0000, v67
  v_lshlrev_b32 v97, 16, v67
  v_and_b32 v98, 0xffff0000, v66
  v_lshlrev_b32 v99, 16, v66
  v_fma_f32 v20, v96, v12, v20
  v_fma_f32 v21, v97, v13, v21
  v_fma_f32 v22, v98, v12, v22
  v_fma_f32 v23, v99, v13, v23
  v_cvt_pk_bf16_f32 v66, v20, v21
  v_cvt_pk_bf16_f32 v67, v22, v23
  ds_write_b64 v10, v[66:67] offset:512
  v_and_b32 v96, 0xffff0000, v69
  v_lshlrev_b32 v97, 16, v69
  v_and_b32 v98, 0xffff0000, v68
  v_lshlrev_b32 v99, 16, v68
  v_fma_f32 v24, v96, v12, v24
  v_fma_f32 v25, v97, v13, v25
  v_fma_f32 v26, v98, v12, v26
  v_fma_f32 v27, v99, v13, v27
  v_cvt_pk_bf16_f32 v68, v24, v25
  v_cvt_pk_bf16_f32 v69, v26, v27
  ds_write_b64 v10, v[68:69] offset:1024
  v_and_b32 v96, 0xffff0000, v71
  v_lshlrev_b32 v97, 16, v71
  v_and_b32 v98, 0xffff0000, v70
  v_lshlrev_b32 v99, 16, v70
  v_fma_f32 v28, v96, v12, v28
  v_fma_f32 v29, v97, v13, v29
  v_fma_f32 v30, v98, v12, v30
  v_fma_f32 v31, v99, v13, v31
  v_cvt_pk_bf16_f32 v70, v28, v29
  v_cvt_pk_bf16_f32 v71, v30, v31
  ds_write_b64 v10, v[70:71] offset:1536
  v_and_b32 v96, 0xffff0000, v73
  v_lshlrev_b32 v97, 16, v73
  v_and_b32 v98, 0xffff0000, v72
  v_lshlrev_b32 v99, 16, v72
  v_fma_f32 v32, v96, v12, v32
  v_fma_f32 v33, v97, v13, v33
  v_fma_f32 v34, v98, v12, v34
  v_fma_f32 v35, v99, v13, v35
  v_cvt_pk_bf16_f32 v72, v32, v33
  v_cvt_pk_bf16_f32 v73, v34, v35
  ds_write_b64 v10, v[72:73] offset:2048
  v_and_b32 v96, 0xffff0000, v75
  v_lshlrev_b32 v97, 16, v75
  v_and_b32 v98, 0xffff0000, v74
  v_lshlrev_b32 v99, 16, v74
  v_fma_f32 v36, v96, v12, v36
  v_fma_f32 v37, v97, v13, v37
  v_fma_f32 v38, v98, v12, v38
  v_fma_f32 v39, v99, v13, v39
  v_cvt_pk_bf16_f32 v74, v36, v37
  v_cvt_pk_bf16_f32 v75, v38, v39
  ds_write_b64 v10, v[74:75] offset:2560
  v_and_b32 v96, 0xffff0000, v77
  v_lshlrev_b32 v97, 16, v77
  v_and_b32 v98, 0xffff0000, v76
  v_lshlrev_b32 v99, 16, v76
  v_fma_f32 v40, v96, v12, v40
  v_fma_f32 v41, v97, v13, v41
  v_fma_f32 v42, v98, v12, v42
  v_fma_f32 v43, v99, v13, v43
  v_cvt_pk_bf16_f32 v76, v40, v41
  v_cvt_pk_bf16_f32 v77, v42, v43
  ds_write_b64 v10, v[76:77] offset:3072
  v_and_b32 v96, 0xffff0000, v79
  v_lshlrev_b32 v97, 16, v79
  v_and_b32 v98, 0xffff0000, v78
  v_lshlrev_b32 v99, 16, v78
  v_fma_f32 v44, v96, v12, v44
  v_fma_f32 v45, v97, v13, v45
  v_fma_f32 v46, v98, v12, v46
  v_fma_f32 v47, v99, v13, v47
  v_cvt_pk_bf16_f32 v78, v44, v45
  v_cvt_pk_bf16_f32 v79, v46, v47
  ds_write_b64 v10, v[78:79] offset:3584
  s_waitcnt lgkmcnt(0)
  v_add_u32 v10, s85, v4
  ds_read_b128 v[96:99], v10 offset:0
  ds_read_b128 v[100:103], v10 offset:1024
  ds_read_b128 v[104:107], v10 offset:2048
  ds_read_b128 v[108:111], v10 offset:3072
  s_lshl_b32 s10, s84, 12
  s_add_u32 s10, s10, 0x600000
  s_waitcnt lgkmcnt(0)
  s_lshl_b32 s11, s3, 2
  s_add_u32 s11, s11, 157280
  v_mov_b32 v6, s11
  v_mov_b32 v7, 1
  ds_write_b32 v6, v7
  buffer_store_dwordx4 v[96:99], v4, s[56:59], s10 offen offset:0 sc1
  buffer_store_dwordx4 v[100:103], v4, s[56:59], s10 offen offset:1024 sc1
  buffer_store_dwordx4 v[104:107], v4, s[56:59], s10 offen offset:2048 sc1
  buffer_store_dwordx4 v[108:111], v4, s[56:59], s10 offen offset:3072 sc1
  s_lshl_b32 s10, s84, 7
  s_add_u32 s10, s10, 0x50000
  s_waitcnt vmcnt(0)
  v_mov_b32 v6, 0
  s_mov_b64 exec, 1
  buffer_store_dword v5, v6, s[56:59], s10 offen sc1
  s_mov_b64 exec, -1
L_preepi:
  s_mov_b32 s72, s40
  s_mov_b32 s73, s41
  s_mov_b32 s74, 0x280000
  s_mov_b32 s75, 0x20000
  s_mov_b32 s48, s16
  s_mov_b32 s49, s17
  s_mov_b32 s50, 0x280000
  s_mov_b32 s51, 0x20000
  s_mul_i32 s10, s9, 160
  s_add_u32 s12, s36, s10
  s_addc_u32 s13, s37, 0
  s_lshl_b32 s11, s8, 6
  s_mul_i32 s11, s11, 1280
  s_add_u32 s14, s11, s10
  v_subrev_u32 v120, 256, v0
  v_mul_u32_u24 v96, 6554, v120
  v_lshrrev_b32 v96, 16, v96
  v_mul_u32_u24 v97, 10, v96
  v_sub_u32 v97, v120, v97
  v_lshlrev_b32 v101, 4, v97
  global_load_dwordx4 v[104:107], v101, s[12:13]
  v_mul_u32_u24 v102, 1280, v96
  v_add_u32 v101, v101, v102
  buffer_load_dwordx4 v[108:111], v101, s[48:51], s14 offen
  v_mul_u32_u24 v98, 336, v96
  v_lshl_add_u32 v98, v97, 5, v98
  v_lshlrev_b32 v126, 1, v97
  v_mul_u32_u24 v124, 13108, v126
  v_lshrrev_b32 v124, 16, v124
  v_mul_u32_u24 v125, 5, v124
  v_sub_u32 v125, v126, v125
  v_mul_u32_u24 v99, 40, v96
  v_lshl_add_u32 v99, v125, 3, v99
  v_mov_b32 v125, 107008
  v_cmp_eq_u32 vcc, 1, v124
  v_mov_b32 v127, 160256
  s_nop 0
  v_cndmask_b32 v125, v125, v127, vcc
  v_cmp_eq_u32 vcc, 2, v124
  v_mov_b32 v127, 117248
  s_nop 0
  v_cndmask_b32 v125, v125, v127, vcc
  v_cmp_eq_u32 vcc, 3, v124
  v_mov_b32 v127, 138496
  s_nop 0
  v_cndmask_b32 v125, v125, v127, vcc
  v_add_u32 v99, v99, v125
  v_add_u32 v126, 1, v126
  v_mul_u32_u24 v124, 13108, v126
  v_lshrrev_b32 v124, 16, v124
  v_mul_u32_u24 v125, 5, v124
  v_sub_u32 v125, v126, v125
  v_mul_u32_u24 v103, 40, v96
  v_lshl_add_u32 v103, v125, 3, v103
  v_mov_b32 v125, 107008
  v_cmp_eq_u32 vcc, 1, v124
  v_mov_b32 v127, 160256
  s_nop 0
  v_cndmask_b32 v125, v125, v127, vcc
  v_cmp_eq_u32 vcc, 2, v124
  v_mov_b32 v127, 117248
  s_nop 0
  v_cndmask_b32 v125, v125, v127, vcc
  v_cmp_eq_u32 vcc, 3, v124
  v_mov_b32 v127, 138496
  s_nop 0
  v_cndmask_b32 v125, v125, v127, vcc
  v_add_u32 v103, v103, v125
  v_lshlrev_b32 v100, 2, v96
  v_add_u32 v100, 157440, v100
  v_mul_u32_u24 v128, 6554, v0
  v_lshrrev_b32 v128, 16, v128
  v_mul_u32_u24 v129, 10, v128
  v_sub_u32 v129, v0, v129
  v_lshlrev_b32 v133, 4, v129
  global_load_dwordx4 v[136:139], v133, s[12:13]
  v_mul_u32_u24 v134, 1280, v128
  v_add_u32 v133, v133, v134
  buffer_load_dwordx4 v[140:143], v133, s[48:51], s14 offen
  v_mul_u32_u24 v130, 336, v128
  v_lshl_add_u32 v130, v129, 5, v130
  v_lshlrev_b32 v126, 1, v129
  v_mul_u32_u24 v124, 13108, v126
  v_lshrrev_b32 v124, 16, v124
  v_mul_u32_u24 v125, 5, v124
  v_sub_u32 v125, v126, v125
  v_mul_u32_u24 v131, 40, v128
  v_lshl_add_u32 v131, v125, 3, v131
  v_mov_b32 v125, 107008
  v_cmp_eq_u32 vcc, 1, v124
  v_mov_b32 v127, 160256
  s_nop 0
  v_cndmask_b32 v125, v125, v127, vcc
  v_cmp_eq_u32 vcc, 2, v124
  v_mov_b32 v127, 117248
  s_nop 0
  v_cndmask_b32 v125, v125, v127, vcc
  v_cmp_eq_u32 vcc, 3, v124
  v_mov_b32 v127, 138496
  s_nop 0
  v_cndmask_b32 v125, v125, v127, vcc
  v_add_u32 v131, v131, v125
  v_add_u32 v126, 1, v126
  v_mul_u32_u24 v124, 13108, v126
  v_lshrrev_b32 v124, 16, v124
  v_mul_u32_u24 v125, 5, v124
  v_sub_u32 v125, v126, v125
  v_mul_u32_u24 v135, 40, v128
  v_lshl_add_u32 v135, v125, 3, v135
  v_mov_b32 v125, 107008
  v_cmp_eq_u32 vcc, 1, v124
  v_mov_b32 v127, 160256
  s_nop 0
  v_cndmask_b32 v125, v125, v127, vcc
  v_cmp_eq_u32 vcc, 2, v124
  v_mov_b32 v127, 117248
  s_nop 0
  v_cndmask_b32 v125, v125, v127, vcc
  v_cmp_eq_u32 vcc, 3, v124
  v_mov_b32 v127, 138496
  s_nop 0
  v_cndmask_b32 v125, v125, v127, vcc
  v_add_u32 v135, v135, v125
  v_lshlrev_b32 v132, 2, v128
  v_add_u32 v132, 157440, v132
  v_add_u32 v120, 256, v0
  v_min_u32 v120, 639, v120
  v_mul_u32_u24 v144, 6554, v120
  v_lshrrev_b32 v144, 16, v144
  v_mul_u32_u24 v145, 10, v144
  v_sub_u32 v145, v120, v145
  v_lshlrev_b32 v149, 4, v145
  global_load_dwordx4 v[152:155], v149, s[12:13]
  v_mul_u32_u24 v150, 1280, v144
  v_add_u32 v149, v149, v150
  buffer_load_dwordx4 v[156:159], v149, s[48:51], s14 offen
  v_mul_u32_u24 v146, 336, v144
  v_lshl_add_u32 v146, v145, 5, v146
  v_lshlrev_b32 v126, 1, v145
  v_mul_u32_u24 v124, 13108, v126
  v_lshrrev_b32 v124, 16, v124
  v_mul_u32_u24 v125, 5, v124
  v_sub_u32 v125, v126, v125
  v_mul_u32_u24 v147, 40, v144
  v_lshl_add_u32 v147, v125, 3, v147
  v_mov_b32 v125, 107008
  v_cmp_eq_u32 vcc, 1, v124
  v_mov_b32 v127, 160256
  s_nop 0
  v_cndmask_b32 v125, v125, v127, vcc
  v_cmp_eq_u32 vcc, 2, v124
  v_mov_b32 v127, 117248
  s_nop 0
  v_cndmask_b32 v125, v125, v127, vcc
  v_cmp_eq_u32 vcc, 3, v124
  v_mov_b32 v127, 138496
  s_nop 0
  v_cndmask_b32 v125, v125, v127, vcc
  v_add_u32 v147, v147, v125
  v_add_u32 v126, 1, v126
  v_mul_u32_u24 v124, 13108, v126
  v_lshrrev_b32 v124, 16, v124
  v_mul_u32_u24 v125, 5, v124
  v_sub_u32 v125, v126, v125
  v_mul_u32_u24 v151, 40, v144
  v_lshl_add_u32 v151, v125, 3, v151
  v_mov_b32 v125, 107008
  v_cmp_eq_u32 vcc, 1, v124
  v_mov_b32 v127, 160256
  s_nop 0
  v_cndmask_b32 v125, v125, v127, vcc
  v_cmp_eq_u32 vcc, 2, v124
  v_mov_b32 v127, 117248
  s_nop 0
  v_cndmask_b32 v125, v125, v127, vcc
  v_cmp_eq_u32 vcc, 3, v124
  v_mov_b32 v127, 138496
  s_nop 0
  v_cndmask_b32 v125, v125, v127, vcc
  v_add_u32 v151, v151, v125
  v_lshlrev_b32 v148, 2, v144
  v_add_u32 v148, 157440, v148
  v_lshlrev_b32 v8, 2, v1
  v_add_u32 v8, 157440, v8
  v_mov_b32 v9, 157220
  s_cmp_lg_u32 s3, 4
  s_cbranch_scc1 L_yswait
  s_mov_b32 s92, 0x100000
L_lw_35:
  ds_read_b32 v7, v14 offset:0
  s_waitcnt lgkmcnt(0)
  v_cmp_eq_u32 vcc, 0, v7
  s_nop 0
  s_cbranch_vccz L_lwd_36
  s_sleep 4
  s_sub_u32 s92, s92, 1
  s_cmp_lg_u32 s92, 0
  s_cbranch_scc1 L_lw_35
L_lwd_36:
  s_mov_b32 s92, 0x100000
L_lw_37:
  ds_read_b32 v7, v9 offset:4
  s_waitcnt lgkmcnt(0)
  v_cmp_ne_u32 vcc, v5, v7
  s_nop 0
  s_cbranch_vccz L_lwd_38
  s_sleep 4
  s_sub_u32 s92, s92, 1
  s_cmp_lg_u32 s92, 0
  s_cbranch_scc1 L_lw_37
L_lwd_38:
  v_lshlrev_b32 v6, 7, v1
  v_min_u32 v10, 15, v1
  v_add_u32 v10, 64, v10
  v_lshlrev_b32 v10, 7, v10
  s_mul_i32 s11, s9, 10240
  s_add_u32 s11, s11, 0x50000
  v_lshrrev_b32 v7, 2, v1
  v_lshlrev_b32 v7, 7, v7
  v_and_b32 v11, 3, v1
  v_lshl_add_u32 v7, v11, 3, v7
  s_lshl_b32 s10, s8, 11
  s_add_u32 s10, s10, 0x70000
  s_mov_b32 s92, 0x40000
L_yp:
  buffer_load_dword v18, v6, s[56:59], s11 offen sc1
  buffer_load_dword v19, v10, s[56:59], s11 offen sc1
  buffer_load_dwordx2 v[16:17], v7, s[56:59], s10 offen sc1
  s_waitcnt vmcnt(0)
  v_xor_b32 v18, v18, v5
  v_xor_b32 v19, v19, v5
  v_xor_b32 v17, v17, v5
  v_or3_b32 v18, v18, v19, v17
  v_cmp_ne_u32 vcc, 0, v18
  s_nop 0
  s_cbranch_vccz L_ypd
  s_sleep 4
  s_sub_u32 s92, s92, 1
  s_cmp_lg_u32 s92, 0
  s_cbranch_scc1 L_yp
L_ypd:
  ds_write_b32 v8, v16
  ds_write_b32 v9, v5
L_yswait:
  s_mov_b32 s92, 0x100000
L_lw_39:
  ds_read_b32 v7, v9 offset:0
  s_waitcnt lgkmcnt(0)
  v_cmp_ne_u32 vcc, v5, v7
  s_nop 0
  s_cbranch_vccz L_lwd_40
  s_sleep 4
  s_sub_u32 s92, s92, 1
  s_cmp_lg_u32 s92, 0
  s_cbranch_scc1 L_lw_39
L_lwd_40:
  ds_read_b32 v16, v8
  s_lshl_b32 s10, s9, 2
  s_add_u32 s10, s10, s77
  s_mul_i32 s10, s10, 81920
  s_lshl_b32 s11, s8, 7
  s_add_u32 s10, s10, s11
  s_add_u32 s10, s10, 0x600000
  v_lshlrev_b32 v6, 12, v3
  v_lshl_add_u32 v6, v2, 3, v6
  buffer_load_dwordx2 v[64:65], v6, s[56:59], s10 offen sc1
  s_add_u32 s10, s10, 16384
  buffer_load_dwordx2 v[66:67], v6, s[56:59], s10 offen sc1
  s_add_u32 s10, s10, 16384
  buffer_load_dwordx2 v[68:69], v6, s[56:59], s10 offen sc1
  s_add_u32 s10, s10, 16384
  buffer_load_dwordx2 v[70:71], v6, s[56:59], s10 offen sc1
  s_add_u32 s10, s10, 16384
  buffer_load_dwordx2 v[72:73], v6, s[56:59], s10 offen sc1
  v_lshlrev_b32 v6, 7, v3
  v_lshl_add_u32 v6, v2, 3, v6
  v_add_u32 v6, s98, v6
  v_bfe_u32 v7, v1, 2, 2
  v_lshlrev_b32 v7, 7, v7
  v_lshl_add_u32 v7, v3, 5, v7
  v_and_b32 v8, 3, v1
  v_lshl_add_u32 v7, v8, 3, v7
  v_add_u32 v7, s98, v7
  v_mul_u32_u24 v8, 40, v1
  v_add_u32 v8, s98, v8
  s_waitcnt vmcnt(0) lgkmcnt(0)
  v_mov_b32 v17, v16
  ds_write_b64 v6, v[64:65] offset:0
  ds_write_b64 v6, v[66:67] offset:512
  ds_write_b64 v6, v[68:69] offset:1024
  ds_write_b64 v6, v[70:71] offset:1536
  ds_write_b64 v6, v[72:73] offset:2048
  s_waitcnt lgkmcnt(0)
  ds_read_b64_tr_b16 v[64:65], v7 offset:0
  ds_read_b64_tr_b16 v[66:67], v7 offset:512
  ds_read_b64_tr_b16 v[68:69], v7 offset:1024
  ds_read_b64_tr_b16 v[70:71], v7 offset:1536
  ds_read_b64_tr_b16 v[72:73], v7 offset:2048
  s_waitcnt lgkmcnt(0)
  v_lshlrev_b32 v92, 16, v64
  v_and_b32 v93, 0xffff0000, v64
  v_mul_f32 v92, v92, v16
  v_mul_f32 v93, v93, v17
  v_cvt_pk_bf16_f32 v80, v92, v93
  v_lshlrev_b32 v94, 16, v65
  v_and_b32 v95, 0xffff0000, v65
  v_mul_f32 v94, v94, v16
  v_mul_f32 v95, v95, v17
  v_cvt_pk_bf16_f32 v81, v94, v95
  ds_write_b64 v8, v[80:81] offset:2560
  v_lshlrev_b32 v92, 16, v66
  v_and_b32 v93, 0xffff0000, v66
  v_mul_f32 v92, v92, v16
  v_mul_f32 v93, v93, v17
  v_cvt_pk_bf16_f32 v82, v92, v93
  v_lshlrev_b32 v94, 16, v67
  v_and_b32 v95, 0xffff0000, v67
  v_mul_f32 v94, v94, v16
  v_mul_f32 v95, v95, v17
  v_cvt_pk_bf16_f32 v83, v94, v95
  ds_write_b64 v8, v[82:83] offset:2568
  v_lshlrev_b32 v92, 16, v68
  v_and_b32 v93, 0xffff0000, v68
  v_mul_f32 v92, v92, v16
  v_mul_f32 v93, v93, v17
  v_cvt_pk_bf16_f32 v84, v92, v93
  v_lshlrev_b32 v94, 16, v69
  v_and_b32 v95, 0xffff0000, v69
  v_mul_f32 v94, v94, v16
  v_mul_f32 v95, v95, v17
  v_cvt_pk_bf16_f32 v85, v94, v95
  ds_write_b64 v8, v[84:85] offset:2576
  v_lshlrev_b32 v92, 16, v70
  v_and_b32 v93, 0xffff0000, v70
  v_mul_f32 v92, v92, v16
  v_mul_f32 v93, v93, v17
  v_cvt_pk_bf16_f32 v86, v92, v93
  v_lshlrev_b32 v94, 16, v71
  v_and_b32 v95, 0xffff0000, v71
  v_mul_f32 v94, v94, v16
  v_mul_f32 v95, v95, v17
  v_cvt_pk_bf16_f32 v87, v94, v95
  ds_write_b64 v8, v[86:87] offset:2584
  v_lshlrev_b32 v92, 16, v72
  v_and_b32 v93, 0xffff0000, v72
  v_mul_f32 v92, v92, v16
  v_mul_f32 v93, v93, v17
  v_cvt_pk_bf16_f32 v88, v92, v93
  v_lshlrev_b32 v94, 16, v73
  v_and_b32 v95, 0xffff0000, v73
  v_mul_f32 v94, v94, v16
  v_mul_f32 v95, v95, v17
  v_cvt_pk_bf16_f32 v89, v94, v95
  ds_write_b64 v8, v[88:89] offset:2592
  s_branch L_final2
L_final:
  s_waitcnt lgkmcnt(0)
  s_barrier
  s_branch L_fin_done
L_final2:
  s_waitcnt vmcnt(0) lgkmcnt(0)
  s_barrier
  ds_read_b128 v[160:163], v98 offset:0
  ds_read_b128 v[164:167], v98 offset:16
  ds_read_b128 v[168:171], v98 offset:21504
  ds_read_b128 v[172:175], v98 offset:21520
  ds_read_b128 v[176:179], v98 offset:43008
  ds_read_b128 v[180:183], v98 offset:43024
  ds_read_b128 v[184:187], v98 offset:64512
  ds_read_b128 v[188:191], v98 offset:64528
  ds_read_b64 v[192:193], v99
  ds_read_b64 v[194:195], v103
  ds_read_b32 v196, v100
  ds_read_b128 v[200:203], v130 offset:0
  ds_read_b128 v[204:207], v130 offset:16
  ds_read_b128 v[208:211], v130 offset:21504
  ds_read_b128 v[212:215], v130 offset:21520
  ds_read_b128 v[216:219], v130 offset:43008
  ds_read_b128 v[220:223], v130 offset:43024
  ds_read_b128 v[224:227], v130 offset:64512
  ds_read_b128 v[228:231], v130 offset:64528
  ds_read_b64 v[232:233], v131
  ds_read_b64 v[234:235], v135
  ds_read_b32 v236, v132
  s_waitcnt lgkmcnt(11)
  v_sub_f32 v8, 1.0, v196
  v_mov_b32 v9, v8
  v_lshlrev_b32 v12, 16, v104
  v_and_b32 v13, 0xffff0000, v104
  v_lshlrev_b32 v14, 16, v192
  v_and_b32 v15, 0xffff0000, v192
  v_lshlrev_b32 v10, 16, v108
  v_and_b32 v11, 0xffff0000, v108
  v_pk_add_f32 v[160:161], v[160:161], v[168:169]
  v_pk_add_f32 v[176:177], v[176:177], v[184:185]
  v_pk_add_f32 v[160:161], v[160:161], v[12:13]
  v_pk_mul_f32 v[14:15], v[14:15], v[10:11]
  v_pk_add_f32 v[160:161], v[160:161], v[176:177]
  v_pk_fma_f32 v[160:161], v[160:161], v[8:9], v[14:15]
  v_cvt_pk_bf16_f32 v104, v160, v161
  v_lshlrev_b32 v12, 16, v105
  v_and_b32 v13, 0xffff0000, v105
  v_lshlrev_b32 v14, 16, v193
  v_and_b32 v15, 0xffff0000, v193
  v_lshlrev_b32 v10, 16, v109
  v_and_b32 v11, 0xffff0000, v109
  v_pk_add_f32 v[162:163], v[162:163], v[170:171]
  v_pk_add_f32 v[178:179], v[178:179], v[186:187]
  v_pk_add_f32 v[162:163], v[162:163], v[12:13]
  v_pk_mul_f32 v[14:15], v[14:15], v[10:11]
  v_pk_add_f32 v[162:163], v[162:163], v[178:179]
  v_pk_fma_f32 v[162:163], v[162:163], v[8:9], v[14:15]
  v_cvt_pk_bf16_f32 v105, v162, v163
  v_lshlrev_b32 v12, 16, v106
  v_and_b32 v13, 0xffff0000, v106
  v_lshlrev_b32 v14, 16, v194
  v_and_b32 v15, 0xffff0000, v194
  v_lshlrev_b32 v10, 16, v110
  v_and_b32 v11, 0xffff0000, v110
  v_pk_add_f32 v[164:165], v[164:165], v[172:173]
  v_pk_add_f32 v[180:181], v[180:181], v[188:189]
  v_pk_add_f32 v[164:165], v[164:165], v[12:13]
  v_pk_mul_f32 v[14:15], v[14:15], v[10:11]
  v_pk_add_f32 v[164:165], v[164:165], v[180:181]
  v_pk_fma_f32 v[164:165], v[164:165], v[8:9], v[14:15]
  v_cvt_pk_bf16_f32 v106, v164, v165
  v_lshlrev_b32 v12, 16, v107
  v_and_b32 v13, 0xffff0000, v107
  v_lshlrev_b32 v14, 16, v195
  v_and_b32 v15, 0xffff0000, v195
  v_lshlrev_b32 v10, 16, v111
  v_and_b32 v11, 0xffff0000, v111
  v_pk_add_f32 v[166:167], v[166:167], v[174:175]
  v_pk_add_f32 v[182:183], v[182:183], v[190:191]
  v_pk_add_f32 v[166:167], v[166:167], v[12:13]
  v_pk_mul_f32 v[14:15], v[14:15], v[10:11]
  v_pk_add_f32 v[166:167], v[166:167], v[182:183]
  v_pk_fma_f32 v[166:167], v[166:167], v[8:9], v[14:15]
  v_cvt_pk_bf16_f32 v107, v166, v167
  buffer_store_dwordx4 v[104:107], v101, s[72:75], s14 offen
  ds_read_b128 v[16:19], v146 offset:0
  ds_read_b128 v[20:23], v146 offset:16
  ds_read_b128 v[24:27], v146 offset:21504
  ds_read_b128 v[28:31], v146 offset:21520
  ds_read_b128 v[32:35], v146 offset:43008
  ds_read_b128 v[36:39], v146 offset:43024
  ds_read_b128 v[40:43], v146 offset:64512
  ds_read_b128 v[44:47], v146 offset:64528
  ds_read_b64 v[48:49], v147
  ds_read_b64 v[50:51], v151
  ds_read_b32 v52, v148
  s_waitcnt lgkmcnt(11)
  v_sub_f32 v8, 1.0, v236
  v_mov_b32 v9, v8
  v_lshlrev_b32 v12, 16, v136
  v_and_b32 v13, 0xffff0000, v136
  v_lshlrev_b32 v14, 16, v232
  v_and_b32 v15, 0xffff0000, v232
  v_lshlrev_b32 v10, 16, v140
  v_and_b32 v11, 0xffff0000, v140
  v_pk_add_f32 v[200:201], v[200:201], v[208:209]
  v_pk_add_f32 v[216:217], v[216:217], v[224:225]
  v_pk_add_f32 v[200:201], v[200:201], v[12:13]
  v_pk_mul_f32 v[14:15], v[14:15], v[10:11]
  v_pk_add_f32 v[200:201], v[200:201], v[216:217]
  v_pk_fma_f32 v[200:201], v[200:201], v[8:9], v[14:15]
  v_cvt_pk_bf16_f32 v136, v200, v201
  v_lshlrev_b32 v12, 16, v137
  v_and_b32 v13, 0xffff0000, v137
  v_lshlrev_b32 v14, 16, v233
  v_and_b32 v15, 0xffff0000, v233
  v_lshlrev_b32 v10, 16, v141
  v_and_b32 v11, 0xffff0000, v141
  v_pk_add_f32 v[202:203], v[202:203], v[210:211]
  v_pk_add_f32 v[218:219], v[218:219], v[226:227]
  v_pk_add_f32 v[202:203], v[202:203], v[12:13]
  v_pk_mul_f32 v[14:15], v[14:15], v[10:11]
  v_pk_add_f32 v[202:203], v[202:203], v[218:219]
  v_pk_fma_f32 v[202:203], v[202:203], v[8:9], v[14:15]
  v_cvt_pk_bf16_f32 v137, v202, v203
  v_lshlrev_b32 v12, 16, v138
  v_and_b32 v13, 0xffff0000, v138
  v_lshlrev_b32 v14, 16, v234
  v_and_b32 v15, 0xffff0000, v234
  v_lshlrev_b32 v10, 16, v142
  v_and_b32 v11, 0xffff0000, v142
  v_pk_add_f32 v[204:205], v[204:205], v[212:213]
  v_pk_add_f32 v[220:221], v[220:221], v[228:229]
  v_pk_add_f32 v[204:205], v[204:205], v[12:13]
  v_pk_mul_f32 v[14:15], v[14:15], v[10:11]
  v_pk_add_f32 v[204:205], v[204:205], v[220:221]
  v_pk_fma_f32 v[204:205], v[204:205], v[8:9], v[14:15]
  v_cvt_pk_bf16_f32 v138, v204, v205
  v_lshlrev_b32 v12, 16, v139
  v_and_b32 v13, 0xffff0000, v139
  v_lshlrev_b32 v14, 16, v235
  v_and_b32 v15, 0xffff0000, v235
  v_lshlrev_b32 v10, 16, v143
  v_and_b32 v11, 0xffff0000, v143
  v_pk_add_f32 v[206:207], v[206:207], v[214:215]
  v_pk_add_f32 v[222:223], v[222:223], v[230:231]
  v_pk_add_f32 v[206:207], v[206:207], v[12:13]
  v_pk_mul_f32 v[14:15], v[14:15], v[10:11]
  v_pk_add_f32 v[206:207], v[206:207], v[222:223]
  v_pk_fma_f32 v[206:207], v[206:207], v[8:9], v[14:15]
  v_cvt_pk_bf16_f32 v139, v206, v207
  buffer_store_dwordx4 v[136:139], v133, s[72:75], s14 offen
  s_cmp_ge_u32 s3, 6
  s_cbranch_scc1 L_fin_done
  s_waitcnt lgkmcnt(0)
  v_sub_f32 v8, 1.0, v52
  v_mov_b32 v9, v8
  v_lshlrev_b32 v12, 16, v152
  v_and_b32 v13, 0xffff0000, v152
  v_lshlrev_b32 v14, 16, v48
  v_and_b32 v15, 0xffff0000, v48
  v_lshlrev_b32 v10, 16, v156
  v_and_b32 v11, 0xffff0000, v156
  v_pk_add_f32 v[16:17], v[16:17], v[24:25]
  v_pk_add_f32 v[32:33], v[32:33], v[40:41]
  v_pk_add_f32 v[16:17], v[16:17], v[12:13]
  v_pk_mul_f32 v[14:15], v[14:15], v[10:11]
  v_pk_add_f32 v[16:17], v[16:17], v[32:33]
  v_pk_fma_f32 v[16:17], v[16:17], v[8:9], v[14:15]
  v_cvt_pk_bf16_f32 v152, v16, v17
  v_lshlrev_b32 v12, 16, v153
  v_and_b32 v13, 0xffff0000, v153
  v_lshlrev_b32 v14, 16, v49
  v_and_b32 v15, 0xffff0000, v49
  v_lshlrev_b32 v10, 16, v157
  v_and_b32 v11, 0xffff0000, v157
  v_pk_add_f32 v[18:19], v[18:19], v[26:27]
  v_pk_add_f32 v[34:35], v[34:35], v[42:43]
  v_pk_add_f32 v[18:19], v[18:19], v[12:13]
  v_pk_mul_f32 v[14:15], v[14:15], v[10:11]
  v_pk_add_f32 v[18:19], v[18:19], v[34:35]
  v_pk_fma_f32 v[18:19], v[18:19], v[8:9], v[14:15]
  v_cvt_pk_bf16_f32 v153, v18, v19
  v_lshlrev_b32 v12, 16, v154
  v_and_b32 v13, 0xffff0000, v154
  v_lshlrev_b32 v14, 16, v50
  v_and_b32 v15, 0xffff0000, v50
  v_lshlrev_b32 v10, 16, v158
  v_and_b32 v11, 0xffff0000, v158
  v_pk_add_f32 v[20:21], v[20:21], v[28:29]
  v_pk_add_f32 v[36:37], v[36:37], v[44:45]
  v_pk_add_f32 v[20:21], v[20:21], v[12:13]
  v_pk_mul_f32 v[14:15], v[14:15], v[10:11]
  v_pk_add_f32 v[20:21], v[20:21], v[36:37]
  v_pk_fma_f32 v[20:21], v[20:21], v[8:9], v[14:15]
  v_cvt_pk_bf16_f32 v154, v20, v21
  v_lshlrev_b32 v12, 16, v155
  v_and_b32 v13, 0xffff0000, v155
  v_lshlrev_b32 v14, 16, v51
  v_and_b32 v15, 0xffff0000, v51
  v_lshlrev_b32 v10, 16, v159
  v_and_b32 v11, 0xffff0000, v159
  v_pk_add_f32 v[22:23], v[22:23], v[30:31]
  v_pk_add_f32 v[38:39], v[38:39], v[46:47]
  v_pk_add_f32 v[22:23], v[22:23], v[12:13]
  v_pk_mul_f32 v[14:15], v[14:15], v[10:11]
  v_pk_add_f32 v[22:23], v[22:23], v[38:39]
  v_pk_fma_f32 v[22:23], v[22:23], v[8:9], v[14:15]
  v_cvt_pk_bf16_f32 v155, v22, v23
  buffer_store_dwordx4 v[152:155], v149, s[72:75], s14 offen
L_fin_done:
L_end:
  s_endpgm
.section .rodata,"a"
.p2align 6
.amdhsa_kernel gated_mix__ssm_conv_h3__dense_activation_gelu__prompt_kernel
  .amdhsa_next_free_vgpr 256
  .amdhsa_next_free_sgpr 102
  .amdhsa_accum_offset 256
  .amdhsa_group_segment_fixed_size 0
  .amdhsa_kernarg_size 120
  .amdhsa_user_sgpr_count 2
  .amdhsa_user_sgpr_kernarg_segment_ptr 1
  .amdhsa_system_sgpr_workgroup_id_x 1
  .amdhsa_float_denorm_mode_32 3
.end_amdhsa_kernel
```
